```python
import torch

def _softmax(x, axis=-1):
    return torch.softmax(x, dim=axis)
def _gelu(x):
    return torch.nn.functional.gelu(x, approximate="tanh")
def _silu(x):
    return torch.nn.functional.silu(x)
def _sigmoid(x):
    return torch.sigmoid(x)
def _layernorm(x, axis=-1, eps=1e-5):
    m = x.mean(dim=axis, keepdim=True)
    v = x.var(dim=axis, keepdim=True, unbiased=False)
    return (x - m) / torch.sqrt(v + eps)
def _scatter_add(tgt, idx, src, axis=0):
    return tgt.clone().index_add_(axis, idx, src)
def _segment_sum(src, seg, n):
    out = torch.zeros((n,) + src.shape[1:], dtype=src.dtype)
    return out.index_add_(0, seg, src)
def _pad(x, pw):
    flat = tuple(v for pair in reversed(pw) for v in pair)
    return torch.nn.functional.pad(x, flat)

kernel_name = 'sequential_preLN__gqa_block_cached__geglu_ffn__decode'

def setup_inputs():

    _w = (lambda a: (lambda t: t.to(torch.bfloat16) if t.is_floating_point() else t)(torch.as_tensor(a)))
    def _A_setup():
        B, Sq, D = 1, 1, 448
        Hq, Hkv, Sk, Dh = 16, 8, 8192, 256
        assert Hq % Hkv == 0, (Hq, Hkv)
        return {
            "x": _w((lambda *s: torch.randn(*s, dtype=torch.bfloat16) * 0.05)(B, Sq, D)),
            "k_cache": _w((lambda *s: torch.randn(*s, dtype=torch.bfloat16) * 3.2)(B, Hkv, Sk, Dh)),
            "v_cache": _w((lambda *s: torch.randn(*s, dtype=torch.bfloat16) * 0.4)(B, Hkv, Sk, Dh)),
            "wq": _w((lambda *s: torch.randn(*s, dtype=torch.bfloat16) * 3.2)(D, Hq * Dh) * (D ** -0.5)),
            "wo": _w((lambda *s: torch.randn(*s, dtype=torch.bfloat16) * 0.4)(Hq * Dh, D) * ((Hq * Dh) ** -0.5)),
        }
    _A_in = _A_setup()

    def _B_setup():
        B, S, D, F = 1, 1, 448, 1792
        return {
            "x": _w((lambda *s: torch.randn(*s, dtype=torch.bfloat16) * 0.05)(B, S, D)),
            "w_gate": _w((lambda *s: torch.randn(*s, dtype=torch.bfloat16) * 0.05)(D, F)),
            "w_up": _w((lambda *s: torch.randn(*s, dtype=torch.bfloat16) * 0.05)(D, F)),
            "w_down": _w((lambda *s: torch.randn(*s, dtype=torch.bfloat16) * 0.05)(F, D)),
        }
    _B_in = _B_setup()

    return {
        "A_x": _A_in["x"],
        "A_k_cache": _A_in["k_cache"],
        "A_v_cache": _A_in["v_cache"],
        "A_wq": _A_in["wq"],
        "A_wo": _A_in["wo"],
        "B_x": _B_in["x"],
        "B_w_gate": _B_in["w_gate"],
        "B_w_up": _B_in["w_up"],
        "B_w_down": _B_in["w_down"],
    }

def reference(A_x, A_k_cache, A_v_cache, A_wq, A_wo, B_x, B_w_gate, B_w_up, B_w_down):
    def _A_ref(x, k_cache, v_cache, wq, wo):
        B, Sq, D = x.shape
        Hq, Dh = 16, 256
        Hkv = k_cache.shape[1]
        rep = Hq // Hkv
        q = (lambda x, *d: x.permute(*d))((x @ wq).reshape(B, Sq, Hq, Dh), 0, 2, 1, 3)
        k = (lambda x, n, axis: torch.repeat_interleave(x, n, dim=axis))(k_cache, rep, axis=1)
        v = (lambda x, n, axis: torch.repeat_interleave(x, n, dim=axis))(v_cache, rep, axis=1)
        scores = torch.einsum("bhqd,bhkd->bhqk", q, k) * (Dh ** -0.5)
        p = _softmax(scores, axis=-1)
        o = torch.einsum("bhqk,bhkd->bhqd", p, v)
        return (lambda x, *d: x.permute(*d))(o, 0, 2, 1, 3).reshape(B, Sq, Hq * Dh) @ wo

    def _B_ref(x, w_gate, w_up, w_down):
        return (_gelu(x @ w_gate) * (x @ w_up)) @ w_down

    x = A_x
    h = x + _A_ref(_layernorm(x, axis=-1), A_k_cache, A_v_cache, A_wq, A_wo)
    h2 = h + _B_ref(_layernorm(h, axis=-1), B_w_gate, B_w_up, B_w_down)
    return h2
```

```asm
; @launch grid=(256,1,1) block=(512,1,1) lds=104192
.amdgcn_target "amdgcn-amd-amdhsa--gfx950"
.text
.globl sequential_preLN__gqa_block_cached__geglu_ffn__decode_kernel
.p2align 8
.type sequential_preLN__gqa_block_cached__geglu_ffn__decode_kernel,@function
sequential_preLN__gqa_block_cached__geglu_ffn__decode_kernel:
    s_cmp_ge_u32 s2, 0x100
    s_cbranch_scc1 L_END2
    s_load_dwordx16 s[16:31], s[0:1], 0
    s_load_dwordx8 s[32:39], s[0:1], 64
    v_and_b32 v1, 63, v0
    v_lshrrev_b32 v7, 6, v0
    s_lshr_b32 s4, s2, 5
    s_and_b32 s5, s2, 31
    v_readfirstlane_b32 s3, v7
    s_mov_b32 s7, 0
    s_min_u32 s15, s2, 111
    s_sub_u32 s14, s2, 128
    s_and_b32 s13, s14, 7
    s_mul_i32 s13, s13, 7
    s_lshr_b32 s14, s14, 3
    s_add_u32 s13, s13, s14
    s_min_u32 s51, s13, 55
    s_mov_b32 s40, 0xffff0000
    s_mov_b32 s41, 0
    s_mov_b32 s42, 0
    s_mov_b32 s43, 0x0000ffff
    s_mov_b32 s44, 0
    s_mov_b32 s45, 0xffff0000
    s_mov_b32 s46, 0x05040100
    s_mov_b32 s47, 0x07060302
    s_mov_b32 s50, 0x3fb8aa3b
    s_mov_b32 s56, -1
    s_mov_b32 s57, 0x00ffffff
    v_cmp_gt_u32 vcc, 0xe0, v0
    s_mov_b64 s[54:55], vcc
    v_mov_b32 v2, 0
    v_mov_b32 v3, 0
    v_mov_b32 v4, 0
    v_mov_b32 v5, 0
    v_lshlrev_b32 v16, 4, v1
    v_mov_b32 v17, 0
    s_lshl_b32 s13, s15, 3
    v_mov_b32 v15, s13
    s_lshr_b32 s8, s5, 3
    s_and_b32 s9, s5, 7
    s_mul_i32 s10, s8, 917504
    s_lshl_b32 s11, s4, 10
    s_lshl_b32 s12, s9, 7
    s_add_u32 s10, s10, s11
    s_add_u32 s10, s10, s12
    v_lshrrev_b32 v18, 5, v0
    v_and_b32 v19, 31, v0
    v_mul_u32_u24 v20, 57344, v18
    v_lshl_add_u32 v20, v19, 2, v20
    v_add_u32 v20, s10, v20
    s_lshl_b32 s11, s4, 22
    s_lshl_b32 s12, s5, 17
    s_add_u32 s11, s11, s12
    s_and_b32 s12, s3, 3
    s_lshl_b32 s12, s12, 15
    s_add_u32 s11, s11, s12
    v_and_b32 v22, 15, v1
    v_lshrrev_b32 v23, 4, v1
    s_waitcnt lgkmcnt(0)
    global_load_dword v6, v17, s[38:39] sc1
    s_mov_b64 exec, s[56:57]
    global_load_dwordx4 v[2:5], v16, s[16:17]
    s_mov_b64 exec, -1
    global_load_dwordx2 v[62:63], v15, s[16:17]
    s_mov_b64 s[52:53], s[22:23]
    global_load_dword v8, v20, s[52:53]
    s_add_u32 s52, s52, 8192
    s_addc_u32 s53, s53, 0
    global_load_dword v9, v20, s[52:53]
    s_add_u32 s52, s52, 8192
    s_addc_u32 s53, s53, 0
    global_load_dword v10, v20, s[52:53]
    s_add_u32 s52, s52, 8192
    s_addc_u32 s53, s53, 0
    global_load_dword v11, v20, s[52:53]
    s_add_u32 s52, s52, 8192
    s_addc_u32 s53, s53, 0
    global_load_dword v12, v20, s[52:53]
    s_add_u32 s52, s52, 8192
    s_addc_u32 s53, s53, 0
    global_load_dword v13, v20, s[52:53]
    s_add_u32 s52, s52, 8192
    s_addc_u32 s53, s53, 0
    global_load_dword v14, v20, s[52:53]
    s_barrier
    s_cmp_ge_u32 s3, 4
    s_cbranch_scc1 L_VPATH
    v_lshlrev_b32 v21, 9, v22
    v_lshl_add_u32 v21, v23, 4, v21
    v_add_u32 v21, s11, v21
    global_load_dwordx4 v[64:67], v21, s[18:19] offset:0
    global_load_dwordx4 v[68:71], v21, s[18:19] offset:64
    global_load_dwordx4 v[72:75], v21, s[18:19] offset:128
    global_load_dwordx4 v[76:79], v21, s[18:19] offset:192
    global_load_dwordx4 v[80:83], v21, s[18:19] offset:256
    global_load_dwordx4 v[84:87], v21, s[18:19] offset:320
    global_load_dwordx4 v[88:91], v21, s[18:19] offset:384
    global_load_dwordx4 v[92:95], v21, s[18:19] offset:448
    v_add_u32 v21, 0x2000, v21
    s_waitcnt vmcnt(15)
    v_readfirstlane_b32 s13, v6
    s_mul_i32 s13, s13, 1664525
    s_add_u32 s6, s13, 1013904223
    v_mov_b32 v6, s6
    v_lshlrev_b32 v24, 16, v2
    v_and_b32 v25, 0xffff0000, v2
    v_lshlrev_b32 v26, 16, v3
    v_and_b32 v27, 0xffff0000, v3
    v_lshlrev_b32 v28, 16, v4
    v_and_b32 v29, 0xffff0000, v4
    v_lshlrev_b32 v30, 16, v5
    v_and_b32 v31, 0xffff0000, v5
    v_add_f32 v32, v24, v25
    v_add_f32 v32, v32, v26
    v_add_f32 v32, v32, v27
    v_add_f32 v32, v32, v28
    v_add_f32 v32, v32, v29
    v_add_f32 v32, v32, v30
    v_add_f32 v32, v32, v31
    s_nop 1
    v_add_f32_dpp v32, v32, v32 row_ror:1 row_mask:0xf bank_mask:0xf
    s_nop 1
    v_add_f32_dpp v32, v32, v32 row_ror:2 row_mask:0xf bank_mask:0xf
    s_nop 1
    v_add_f32_dpp v32, v32, v32 row_ror:4 row_mask:0xf bank_mask:0xf
    s_nop 1
    v_add_f32_dpp v32, v32, v32 row_ror:8 row_mask:0xf bank_mask:0xf
    v_mov_b32 v33, v32
    s_nop 1
    v_permlane16_swap_b32 v32, v33
    v_add_f32 v32, v32, v33
    v_mov_b32 v33, v32
    s_nop 1
    v_permlane32_swap_b32 v32, v33
    v_add_f32 v32, v32, v33
    v_mul_f32 v34, 0x3b124925, v32
    v_mov_b32 v36, 0
    s_mov_b64 exec, s[56:57]
    v_sub_f32 v37, v24, v34
    v_fmac_f32 v36, v37, v37
    v_sub_f32 v37, v25, v34
    v_fmac_f32 v36, v37, v37
    v_sub_f32 v37, v26, v34
    v_fmac_f32 v36, v37, v37
    v_sub_f32 v37, v27, v34
    v_fmac_f32 v36, v37, v37
    v_sub_f32 v37, v28, v34
    v_fmac_f32 v36, v37, v37
    v_sub_f32 v37, v29, v34
    v_fmac_f32 v36, v37, v37
    v_sub_f32 v37, v30, v34
    v_fmac_f32 v36, v37, v37
    v_sub_f32 v37, v31, v34
    v_fmac_f32 v36, v37, v37
    s_mov_b64 exec, -1
    s_nop 1
    v_add_f32_dpp v36, v36, v36 row_ror:1 row_mask:0xf bank_mask:0xf
    s_nop 1
    v_add_f32_dpp v36, v36, v36 row_ror:2 row_mask:0xf bank_mask:0xf
    s_nop 1
    v_add_f32_dpp v36, v36, v36 row_ror:4 row_mask:0xf bank_mask:0xf
    s_nop 1
    v_add_f32_dpp v36, v36, v36 row_ror:8 row_mask:0xf bank_mask:0xf
    v_mov_b32 v33, v36
    s_nop 1
    v_permlane16_swap_b32 v36, v33
    v_add_f32 v36, v36, v33
    v_mov_b32 v33, v36
    s_nop 1
    v_permlane32_swap_b32 v36, v33
    v_add_f32 v36, v36, v33
    v_mul_f32 v36, 0x3b124925, v36
    v_cvt_pk_bf16_f32 v33, v36, v36
    v_lshlrev_b32 v36, 16, v33
    v_add_f32 v36, 0x3727c5ac, v36
    v_cvt_pk_bf16_f32 v33, v36, v36
    v_lshlrev_b32 v36, 16, v33
    v_sqrt_f32 v38, v36
    v_mov_b32 v35, v34
    v_cvt_pk_bf16_f32 v33, v35, v35
    v_lshlrev_b32 v35, 16, v33
    v_cvt_pk_bf16_f32 v33, v38, v38
    v_lshlrev_b32 v38, 16, v33
    v_rcp_f32 v39, v38
    v_sub_f32 v24, v24, v35
    v_cvt_pk_bf16_f32 v33, v24, v24
    v_lshlrev_b32 v24, 16, v33
    v_sub_f32 v25, v25, v35
    v_cvt_pk_bf16_f32 v33, v25, v25
    v_lshlrev_b32 v25, 16, v33
    v_sub_f32 v26, v26, v35
    v_cvt_pk_bf16_f32 v33, v26, v26
    v_lshlrev_b32 v26, 16, v33
    v_sub_f32 v27, v27, v35
    v_cvt_pk_bf16_f32 v33, v27, v27
    v_lshlrev_b32 v27, 16, v33
    v_sub_f32 v28, v28, v35
    v_cvt_pk_bf16_f32 v33, v28, v28
    v_lshlrev_b32 v28, 16, v33
    v_sub_f32 v29, v29, v35
    v_cvt_pk_bf16_f32 v33, v29, v29
    v_lshlrev_b32 v29, 16, v33
    v_sub_f32 v30, v30, v35
    v_cvt_pk_bf16_f32 v33, v30, v30
    v_lshlrev_b32 v30, 16, v33
    v_sub_f32 v31, v31, v35
    v_cvt_pk_bf16_f32 v33, v31, v31
    v_lshlrev_b32 v31, 16, v33
    v_mul_f32 v37, v24, v39
    v_fma_f32 v33, -v37, v38, v24
    v_fma_f32 v24, v33, v39, v37
    v_cvt_pk_bf16_f32 v33, v24, v24
    v_lshlrev_b32 v24, 16, v33
    v_mul_f32 v37, v25, v39
    v_fma_f32 v33, -v37, v38, v25
    v_fma_f32 v25, v33, v39, v37
    v_cvt_pk_bf16_f32 v33, v25, v25
    v_lshlrev_b32 v25, 16, v33
    v_mul_f32 v37, v26, v39
    v_fma_f32 v33, -v37, v38, v26
    v_fma_f32 v26, v33, v39, v37
    v_cvt_pk_bf16_f32 v33, v26, v26
    v_lshlrev_b32 v26, 16, v33
    v_mul_f32 v37, v27, v39
    v_fma_f32 v33, -v37, v38, v27
    v_fma_f32 v27, v33, v39, v37
    v_cvt_pk_bf16_f32 v33, v27, v27
    v_lshlrev_b32 v27, 16, v33
    v_mul_f32 v37, v28, v39
    v_fma_f32 v33, -v37, v38, v28
    v_fma_f32 v28, v33, v39, v37
    v_cvt_pk_bf16_f32 v33, v28, v28
    v_lshlrev_b32 v28, 16, v33
    v_mul_f32 v37, v29, v39
    v_fma_f32 v33, -v37, v38, v29
    v_fma_f32 v29, v33, v39, v37
    v_cvt_pk_bf16_f32 v33, v29, v29
    v_lshlrev_b32 v29, 16, v33
    v_mul_f32 v37, v30, v39
    v_fma_f32 v33, -v37, v38, v30
    v_fma_f32 v30, v33, v39, v37
    v_cvt_pk_bf16_f32 v33, v30, v30
    v_lshlrev_b32 v30, 16, v33
    v_mul_f32 v37, v31, v39
    v_fma_f32 v33, -v37, v38, v31
    v_fma_f32 v31, v33, v39, v37
    v_cvt_pk_bf16_f32 v33, v31, v31
    v_lshlrev_b32 v31, 16, v33
    v_lshlrev_b32 v16, 5, v1
    s_mov_b64 exec, s[56:57]
    ds_write_b128 v16, v[24:27] offset:0
    ds_write_b128 v16, v[28:31] offset:16
    s_mov_b64 exec, -1
    s_mul_i32 s13, s8, 448
    v_mul_u32_u24 v16, 28, v18
    v_add_u32 v16, s13, v16
    s_waitcnt lgkmcnt(0)
    ds_read_b32 v24, v16 offset:0
    ds_read_b32 v25, v16 offset:4
    ds_read_b32 v26, v16 offset:8
    ds_read_b32 v27, v16 offset:12
    ds_read_b32 v28, v16 offset:16
    ds_read_b32 v29, v16 offset:20
    ds_read_b32 v30, v16 offset:24
    v_mov_b32 v32, 0
    v_mov_b32 v33, 0
    s_waitcnt vmcnt(8) lgkmcnt(0)
    v_lshlrev_b32 v34, 16, v8
    v_and_b32 v35, 0xffff0000, v8
    v_fmac_f32 v32, v24, v34
    v_fmac_f32 v33, v24, v35
    v_lshlrev_b32 v34, 16, v9
    v_and_b32 v35, 0xffff0000, v9
    v_fmac_f32 v32, v25, v34
    v_fmac_f32 v33, v25, v35
    v_lshlrev_b32 v34, 16, v10
    v_and_b32 v35, 0xffff0000, v10
    v_fmac_f32 v32, v26, v34
    v_fmac_f32 v33, v26, v35
    v_lshlrev_b32 v34, 16, v11
    v_and_b32 v35, 0xffff0000, v11
    v_fmac_f32 v32, v27, v34
    v_fmac_f32 v33, v27, v35
    v_lshlrev_b32 v34, 16, v12
    v_and_b32 v35, 0xffff0000, v12
    v_fmac_f32 v32, v28, v34
    v_fmac_f32 v33, v28, v35
    v_lshlrev_b32 v34, 16, v13
    v_and_b32 v35, 0xffff0000, v13
    v_fmac_f32 v32, v29, v34
    v_fmac_f32 v33, v29, v35
    v_lshlrev_b32 v34, 16, v14
    v_and_b32 v35, 0xffff0000, v14
    v_fmac_f32 v32, v30, v34
    v_fmac_f32 v33, v30, v35
    v_lshlrev_b32 v16, 8, v18
    v_lshl_add_u32 v16, v19, 3, v16
    ds_write_b64 v16, v[32:33] offset:2048
    v_mov_b32 v16, 0
    ds_write_b32 v16, v16 offset:17008
    s_waitcnt lgkmcnt(0)
    s_barrier
    s_cmp_lg_u32 s3, 0
    s_cbranch_scc1 L_QPUB_DONE
    v_lshlrev_b32 v16, 2, v1
    ds_read_b32 v24, v16 offset:2048
    ds_read_b32 v25, v16 offset:2304
    ds_read_b32 v26, v16 offset:2560
    ds_read_b32 v27, v16 offset:2816
    ds_read_b32 v28, v16 offset:3072
    ds_read_b32 v29, v16 offset:3328
    ds_read_b32 v30, v16 offset:3584
    ds_read_b32 v31, v16 offset:3840
    ds_read_b32 v32, v16 offset:4096
    ds_read_b32 v33, v16 offset:4352
    ds_read_b32 v34, v16 offset:4608
    ds_read_b32 v35, v16 offset:4864
    ds_read_b32 v36, v16 offset:5120
    ds_read_b32 v37, v16 offset:5376
    ds_read_b32 v38, v16 offset:5632
    ds_read_b32 v39, v16 offset:5888
    s_lshl_b32 s13, s4, 2
    s_add_u32 s13, s13, s8
    s_lshl_b32 s13, s13, 12
    s_lshl_b32 s14, s9, 9
    s_add_u32 s13, s13, s14
    s_add_u32 s13, s13, 4096
    v_lshlrev_b32 v16, 3, v1
    v_add_u32 v16, s13, v16
    s_waitcnt lgkmcnt(0)
    v_add_f32 v40, v24, v25
    v_add_f32 v40, v40, v26
    v_add_f32 v40, v40, v27
    v_add_f32 v40, v40, v28
    v_add_f32 v40, v40, v29
    v_add_f32 v40, v40, v30
    v_add_f32 v40, v40, v31
    v_add_f32 v40, v40, v32
    v_add_f32 v40, v40, v33
    v_add_f32 v40, v40, v34
    v_add_f32 v40, v40, v35
    v_add_f32 v40, v40, v36
    v_add_f32 v40, v40, v37
    v_add_f32 v40, v40, v38
    v_add_f32 v40, v40, v39
    v_mov_b32 v41, v6
    global_store_dwordx2 v16, v[40:41], s[38:39] sc1
L_QPUB_DONE:
    global_load_dwordx4 v[96:99], v21, s[18:19] offset:0
    global_load_dwordx4 v[100:103], v21, s[18:19] offset:64
    global_load_dwordx4 v[104:107], v21, s[18:19] offset:128
    global_load_dwordx4 v[108:111], v21, s[18:19] offset:192
    global_load_dwordx4 v[112:115], v21, s[18:19] offset:256
    global_load_dwordx4 v[116:119], v21, s[18:19] offset:320
    global_load_dwordx4 v[120:123], v21, s[18:19] offset:384
    global_load_dwordx4 v[124:127], v21, s[18:19] offset:448
    v_add_u32 v21, 0x2000, v21
    global_load_dwordx4 v[128:131], v21, s[18:19] offset:0
    global_load_dwordx4 v[132:135], v21, s[18:19] offset:64
    global_load_dwordx4 v[136:139], v21, s[18:19] offset:128
    global_load_dwordx4 v[140:143], v21, s[18:19] offset:192
    global_load_dwordx4 v[144:147], v21, s[18:19] offset:256
    global_load_dwordx4 v[148:151], v21, s[18:19] offset:320
    global_load_dwordx4 v[152:155], v21, s[18:19] offset:384
    global_load_dwordx4 v[156:159], v21, s[18:19] offset:448
    v_add_u32 v21, 0x2000, v21
    global_load_dwordx4 v[160:163], v21, s[18:19] offset:0
    global_load_dwordx4 v[164:167], v21, s[18:19] offset:64
    global_load_dwordx4 v[168:171], v21, s[18:19] offset:128
    global_load_dwordx4 v[172:175], v21, s[18:19] offset:192
    global_load_dwordx4 v[176:179], v21, s[18:19] offset:256
    global_load_dwordx4 v[180:183], v21, s[18:19] offset:320
    global_load_dwordx4 v[184:187], v21, s[18:19] offset:384
    global_load_dwordx4 v[188:191], v21, s[18:19] offset:448
    s_lshl_b32 s13, s4, 14
    s_add_u32 s13, s13, 8192
    v_lshlrev_b32 v16, 4, v0
    v_add_u32 v16, s13, v16
    v_add_u32 v17, 0x2000, v16
L_poll_q:
    global_load_dwordx4 v[24:27], v16, s[38:39] offset:-4096 sc1
    global_load_dwordx4 v[28:31], v16, s[38:39] sc1
    global_load_dwordx4 v[32:35], v17, s[38:39] offset:-4096 sc1
    global_load_dwordx4 v[36:39], v17, s[38:39] sc1
    s_waitcnt vmcnt(0)
    v_xor_b32 v40, v6, v25
    v_xor_b32 v41, v6, v27
    v_or_b32 v40, v40, v41
    v_xor_b32 v41, v6, v29
    v_xor_b32 v42, v6, v31
    v_or3_b32 v40, v40, v41, v42
    v_xor_b32 v41, v6, v33
    v_xor_b32 v42, v6, v35
    v_or3_b32 v40, v40, v41, v42
    v_xor_b32 v41, v6, v37
    v_xor_b32 v42, v6, v39
    v_or3_b32 v40, v40, v41, v42
    v_cmp_ne_u32 vcc, 0, v40
    s_cbranch_vccz L_poll_q_ok
    s_add_u32 s7, s7, 1
    s_cmp_lt_u32 s7, 400000
    s_cbranch_scc1 L_poll_q
    s_endpgm
L_poll_q_ok:
    v_add_f32 v24, v24, v28
    v_add_f32 v26, v26, v30
    v_add_f32 v24, v24, v32
    v_add_f32 v26, v26, v34
    v_add_f32 v24, v24, v36
    v_add_f32 v26, v26, v38
    v_cvt_pk_bf16_f32 v24, v24, v26
    v_lshlrev_b32 v16, 2, v0
    ds_write_b32 v16, v24 offset:6144
    v_mov_b32 v17, 0
    v_mov_b32 v25, 1
    s_waitcnt lgkmcnt(0)
    s_mov_b64 exec, 1
    ds_add_u32 v17, v25 offset:17008
    s_mov_b64 exec, -1
L_qsync:
    ds_read_b32 v26, v17 offset:17008
    s_waitcnt lgkmcnt(0)
    v_cmp_gt_u32 vcc, 4, v26
    s_cbranch_vccz L_qsync_ok
    s_add_u32 s7, s7, 1
    s_cmp_lt_u32 s7, 3200000
    s_cbranch_scc1 L_qsync
    s_endpgm
L_qsync_ok:
    v_and_b32 v16, 1, v1
    v_lshlrev_b32 v16, 9, v16
    v_lshl_add_u32 v16, v23, 4, v16
    ds_read_b128 v[192:195], v16 offset:6144
    ds_read_b128 v[196:199], v16 offset:6208
    ds_read_b128 v[200:203], v16 offset:6272
    ds_read_b128 v[204:207], v16 offset:6336
    ds_read_b128 v[208:211], v16 offset:6400
    ds_read_b128 v[212:215], v16 offset:6464
    ds_read_b128 v[216:219], v16 offset:6528
    ds_read_b128 v[220:223], v16 offset:6592
    s_waitcnt lgkmcnt(0)
    v_mfma_f32_16x16x32_bf16 v[224:227], v[192:195], v[64:67], 0
    v_mfma_f32_16x16x32_bf16 v[224:227], v[196:199], v[68:71], v[224:227]
    v_mfma_f32_16x16x32_bf16 v[224:227], v[200:203], v[72:75], v[224:227]
    v_mfma_f32_16x16x32_bf16 v[224:227], v[204:207], v[76:79], v[224:227]
    v_mfma_f32_16x16x32_bf16 v[224:227], v[208:211], v[80:83], v[224:227]
    v_mfma_f32_16x16x32_bf16 v[224:227], v[212:215], v[84:87], v[224:227]
    v_mfma_f32_16x16x32_bf16 v[224:227], v[216:219], v[88:91], v[224:227]
    v_mfma_f32_16x16x32_bf16 v[224:227], v[220:223], v[92:95], v[224:227]
    v_mfma_f32_16x16x32_bf16 v[228:231], v[192:195], v[96:99], 0
    v_mfma_f32_16x16x32_bf16 v[228:231], v[196:199], v[100:103], v[228:231]
    v_mfma_f32_16x16x32_bf16 v[228:231], v[200:203], v[104:107], v[228:231]
    v_mfma_f32_16x16x32_bf16 v[228:231], v[204:207], v[108:111], v[228:231]
    v_mfma_f32_16x16x32_bf16 v[228:231], v[208:211], v[112:115], v[228:231]
    v_mfma_f32_16x16x32_bf16 v[228:231], v[212:215], v[116:119], v[228:231]
    v_mfma_f32_16x16x32_bf16 v[228:231], v[216:219], v[120:123], v[228:231]
    v_mfma_f32_16x16x32_bf16 v[228:231], v[220:223], v[124:127], v[228:231]
    v_mfma_f32_16x16x32_bf16 v[232:235], v[192:195], v[128:131], 0
    v_mfma_f32_16x16x32_bf16 v[232:235], v[196:199], v[132:135], v[232:235]
    v_mfma_f32_16x16x32_bf16 v[232:235], v[200:203], v[136:139], v[232:235]
    v_mfma_f32_16x16x32_bf16 v[232:235], v[204:207], v[140:143], v[232:235]
    v_mfma_f32_16x16x32_bf16 v[232:235], v[208:211], v[144:147], v[232:235]
    v_mfma_f32_16x16x32_bf16 v[232:235], v[212:215], v[148:151], v[232:235]
    v_mfma_f32_16x16x32_bf16 v[232:235], v[216:219], v[152:155], v[232:235]
    v_mfma_f32_16x16x32_bf16 v[232:235], v[220:223], v[156:159], v[232:235]
    v_mfma_f32_16x16x32_bf16 v[236:239], v[192:195], v[160:163], 0
    v_mfma_f32_16x16x32_bf16 v[236:239], v[196:199], v[164:167], v[236:239]
    v_mfma_f32_16x16x32_bf16 v[236:239], v[200:203], v[168:171], v[236:239]
    v_mfma_f32_16x16x32_bf16 v[236:239], v[204:207], v[172:175], v[236:239]
    v_mfma_f32_16x16x32_bf16 v[236:239], v[208:211], v[176:179], v[236:239]
    v_mfma_f32_16x16x32_bf16 v[236:239], v[212:215], v[180:183], v[236:239]
    v_mfma_f32_16x16x32_bf16 v[236:239], v[216:219], v[184:187], v[236:239]
    v_mfma_f32_16x16x32_bf16 v[236:239], v[220:223], v[188:191], v[236:239]
    s_nop 7
    s_nop 1
    v_cndmask_b32 v24, v224, v228, s[40:41]
    v_cndmask_b32 v25, v225, v229, s[40:41]
    v_cndmask_b32 v24, v24, v232, s[42:43]
    v_cndmask_b32 v25, v25, v233, s[42:43]
    v_cndmask_b32 v24, v24, v236, s[44:45]
    v_cndmask_b32 v25, v25, v237, s[44:45]
    v_cvt_pk_bf16_f32 v26, v24, v25
    v_lshlrev_b32 v24, 16, v26
    v_and_b32 v25, 0xffff0000, v26
    v_mul_f32 v24, 0x3d800000, v24
    v_mul_f32 v25, 0x3d800000, v25
    v_mov_b32 v28, v24
    v_mov_b32 v29, v25
    s_nop 1
    v_max_f32_dpp v28, v28, v28 row_ror:1 row_mask:0xf bank_mask:0xf
    v_max_f32_dpp v29, v29, v29 row_ror:1 row_mask:0xf bank_mask:0xf
    s_nop 1
    v_max_f32_dpp v28, v28, v28 row_ror:2 row_mask:0xf bank_mask:0xf
    v_max_f32_dpp v29, v29, v29 row_ror:2 row_mask:0xf bank_mask:0xf
    s_nop 1
    v_max_f32_dpp v28, v28, v28 row_ror:4 row_mask:0xf bank_mask:0xf
    v_max_f32_dpp v29, v29, v29 row_ror:4 row_mask:0xf bank_mask:0xf
    s_nop 1
    v_max_f32_dpp v28, v28, v28 row_ror:8 row_mask:0xf bank_mask:0xf
    v_max_f32_dpp v29, v29, v29 row_ror:8 row_mask:0xf bank_mask:0xf
    v_mov_b32 v30, v28
    v_mov_b32 v31, v29
    s_nop 1
    v_permlane16_swap_b32 v28, v30
    v_permlane16_swap_b32 v29, v31
    v_max_f32 v28, v28, v30
    v_max_f32 v29, v29, v31
    v_mov_b32 v30, v28
    v_mov_b32 v31, v29
    s_nop 1
    v_permlane32_swap_b32 v28, v30
    v_permlane32_swap_b32 v29, v31
    v_max_f32 v28, v28, v30
    v_max_f32 v29, v29, v31
    v_sub_f32 v24, v24, v28
    v_sub_f32 v25, v25, v29
    v_mul_f32 v24, s50, v24
    v_mul_f32 v25, s50, v25
    v_exp_f32 v24, v24
    v_exp_f32 v25, v25
    s_nop 0
    v_cvt_pk_bf16_f32 v26, v24, v25
    s_lshl_b32 s13, s3, 8
    v_lshlrev_b32 v16, 1, v1
    v_add_u32 v16, s13, v16
    ds_write_b16 v16, v26 offset:7168
    ds_write_b16_d16_hi v16, v26 offset:7296
    s_nop 1
    v_add_f32_dpp v24, v24, v24 row_ror:1 row_mask:0xf bank_mask:0xf
    v_add_f32_dpp v25, v25, v25 row_ror:1 row_mask:0xf bank_mask:0xf
    s_nop 1
    v_add_f32_dpp v24, v24, v24 row_ror:2 row_mask:0xf bank_mask:0xf
    v_add_f32_dpp v25, v25, v25 row_ror:2 row_mask:0xf bank_mask:0xf
    s_nop 1
    v_add_f32_dpp v24, v24, v24 row_ror:4 row_mask:0xf bank_mask:0xf
    v_add_f32_dpp v25, v25, v25 row_ror:4 row_mask:0xf bank_mask:0xf
    s_nop 1
    v_add_f32_dpp v24, v24, v24 row_ror:8 row_mask:0xf bank_mask:0xf
    v_add_f32_dpp v25, v25, v25 row_ror:8 row_mask:0xf bank_mask:0xf
    v_mov_b32 v30, v24
    v_mov_b32 v31, v25
    s_nop 1
    v_permlane16_swap_b32 v24, v30
    v_permlane16_swap_b32 v25, v31
    v_add_f32 v24, v24, v30
    v_add_f32 v25, v25, v31
    v_mov_b32 v30, v24
    v_mov_b32 v31, v25
    s_nop 1
    v_permlane32_swap_b32 v24, v30
    v_permlane32_swap_b32 v25, v31
    v_add_f32 v24, v24, v30
    v_add_f32 v25, v25, v31
    v_mov_b32 v32, v28
    v_mov_b32 v33, v24
    v_mov_b32 v34, v29
    v_mov_b32 v35, v25
    s_lshl_b32 s13, s3, 4
    v_mov_b32 v16, s13
    s_mov_b64 exec, 1
    ds_write_b128 v16, v[32:35] offset:8192
    s_mov_b64 exec, -1
    s_waitcnt lgkmcnt(0)
    s_barrier
    s_lshr_b32 s8, s2, 3
    s_and_b32 s8, s8, 1
    s_lshr_b32 s10, s2, 4
    s_and_b32 s10, s10, 7
    s_and_b32 s9, s2, 7
    s_lshl_b32 s13, s10, 17
    s_lshl_b32 s14, s8, 11
    s_add_u32 s13, s13, s14
    s_lshl_b32 s14, s9, 8
    s_add_u32 s13, s13, s14
    s_add_u32 s13, s13, 262144
    v_lshrrev_b32 v52, 3, v0
    v_and_b32 v53, 7, v0
    v_lshlrev_b32 v54, 12, v52
    v_lshl_add_u32 v54, v53, 5, v54
    v_add_u32 v54, s13, v54
    s_lshl_b32 s13, s10, 10
    s_lshl_b32 s14, s8, 9
    s_add_u32 s13, s13, s14
    s_add_u32 s13, s13, 139264
    v_and_b32 v55, 31, v1
    v_lshlrev_b32 v55, 4, v55
    v_add_u32 v55, s13, v55
    v_lshrrev_b32 v16, 7, v0
    v_lshlrev_b32 v17, 3, v16
    v_and_b32 v18, 127, v0
    v_lshlrev_b32 v18, 3, v18
    v_lshl_add_u32 v18, v16, 10, v18
    s_lshl_b32 s13, s2, 12
    s_add_u32 s13, s13, 262144
    v_lshlrev_b32 v56, 4, v0
    v_add_u32 v56, s13, v56
    s_lshl_b32 s13, s4, 10
    s_lshl_b32 s14, s5, 4
    s_add_u32 s13, s13, s14
    s_add_u32 s13, s13, 139264
    v_lshlrev_b32 v57, 9, v16
    v_add_u32 v57, s13, v57
    v_and_b32 v58, 127, v0
    v_cmp_eq_u32 vcc, 0, v58
    s_mov_b64 s[60:61], vcc
    s_barrier
    ds_read_b64 v[24:25], v17 offset:8192
    ds_read_b64 v[26:27], v17 offset:8208
    ds_read_b64 v[28:29], v17 offset:8224
    ds_read_b64 v[30:31], v17 offset:8240
    ds_read_b64 v[32:33], v18 offset:8448
    ds_read_b64 v[34:35], v18 offset:10496
    ds_read_b64 v[36:37], v18 offset:12544
    ds_read_b64 v[38:39], v18 offset:14592
    s_waitcnt lgkmcnt(0)
    v_max_f32 v40, v24, v26
    v_max3_f32 v40, v40, v28, v30
    v_sub_f32 v44, v24, v40
    v_mul_f32 v44, s50, v44
    v_exp_f32 v44, v44
    v_sub_f32 v45, v26, v40
    v_mul_f32 v45, s50, v45
    v_exp_f32 v45, v45
    v_sub_f32 v46, v28, v40
    v_mul_f32 v46, s50, v46
    v_exp_f32 v46, v46
    v_sub_f32 v47, v30, v40
    v_mul_f32 v47, s50, v47
    v_exp_f32 v47, v47
    s_nop 0
    v_mul_f32 v42, v44, v25
    v_mul_f32 v48, v44, v32
    v_mul_f32 v50, v44, v33
    v_fmac_f32 v42, v45, v27
    v_fmac_f32 v48, v45, v34
    v_fmac_f32 v50, v45, v35
    v_fmac_f32 v42, v46, v29
    v_fmac_f32 v48, v46, v36
    v_fmac_f32 v50, v46, v37
    v_fmac_f32 v42, v47, v31
    v_fmac_f32 v48, v47, v38
    v_fmac_f32 v50, v47, v39
    v_mov_b32 v49, v6
    v_mov_b32 v51, v6
    v_mov_b32 v41, v6
    v_mov_b32 v43, v6
    global_store_dwordx4 v56, v[48:51], s[38:39] sc1
    s_mov_b64 exec, s[60:61]
    s_cbranch_execz L_NOML
    global_store_dwordx4 v57, v[40:43], s[38:39] sc1
L_NOML:
    s_mov_b64 exec, -1
    s_cmp_ge_u32 s2, 128
    s_cbranch_scc1 L_NOTA
    s_barrier
    s_mov_b64 s[98:99], exec
    s_mov_b64 s[92:93], exec
    s_mov_b64 s[94:95], exec
    global_load_dwordx4 v[64:67], v54, s[38:39] sc1
    global_load_dwordx4 v[68:71], v54, s[38:39] offset:16 sc1
    global_load_dwordx4 v[72:75], v55, s[38:39] sc1
    s_mov_b64 exec, -1
    s_barrier
    v_lshlrev_b32 v17, 2, v0
    v_add_u32 v17, 18176, v17
    ds_read_b32 v128, v17 offset:0
    ds_read_b32 v129, v17 offset:896
    ds_read_b32 v130, v17 offset:1792
    ds_read_b32 v131, v17 offset:2688
    ds_read_b32 v132, v17 offset:3584
    ds_read_b32 v133, v17 offset:4480
    ds_read_b32 v134, v17 offset:5376
    ds_read_b32 v135, v17 offset:6272
    s_waitcnt lgkmcnt(0)
    ds_read_b32 v136, v17 offset:7168
    ds_read_b32 v137, v17 offset:8064
    ds_read_b32 v138, v17 offset:8960
    ds_read_b32 v139, v17 offset:9856
    ds_read_b32 v140, v17 offset:10752
    ds_read_b32 v141, v17 offset:11648
    ds_read_b32 v142, v17 offset:12544
    ds_read_b32 v143, v17 offset:13440
    s_waitcnt lgkmcnt(0)
    ds_read_b32 v144, v17 offset:14336
    ds_read_b32 v145, v17 offset:15232
    ds_read_b32 v146, v17 offset:16128
    ds_read_b32 v147, v17 offset:17024
    ds_read_b32 v148, v17 offset:17920
    ds_read_b32 v149, v17 offset:18816
    ds_read_b32 v150, v17 offset:19712
    ds_read_b32 v151, v17 offset:20608
    s_waitcnt lgkmcnt(0)
    ds_read_b32 v152, v17 offset:21504
    ds_read_b32 v153, v17 offset:22400
    ds_read_b32 v154, v17 offset:23296
    ds_read_b32 v155, v17 offset:24192
    ds_read_b32 v156, v17 offset:25088
    ds_read_b32 v157, v17 offset:25984
    ds_read_b32 v158, v17 offset:26880
    ds_read_b32 v159, v17 offset:27776
    s_waitcnt lgkmcnt(0)
    v_perm_b32 v96, v129, v128, s46
    v_perm_b32 v97, v129, v128, s47
    v_perm_b32 v98, v131, v130, s46
    v_perm_b32 v99, v131, v130, s47
    v_perm_b32 v100, v133, v132, s46
    v_perm_b32 v101, v133, v132, s47
    v_perm_b32 v102, v135, v134, s46
    v_perm_b32 v103, v135, v134, s47
    v_perm_b32 v104, v137, v136, s46
    v_perm_b32 v105, v137, v136, s47
    v_perm_b32 v106, v139, v138, s46
    v_perm_b32 v107, v139, v138, s47
    v_perm_b32 v108, v141, v140, s46
    v_perm_b32 v109, v141, v140, s47
    v_perm_b32 v110, v143, v142, s46
    v_perm_b32 v111, v143, v142, s47
    v_perm_b32 v112, v145, v144, s46
    v_perm_b32 v113, v145, v144, s47
    v_perm_b32 v114, v147, v146, s46
    v_perm_b32 v115, v147, v146, s47
    v_perm_b32 v116, v149, v148, s46
    v_perm_b32 v117, v149, v148, s47
    v_perm_b32 v118, v151, v150, s46
    v_perm_b32 v119, v151, v150, s47
    v_perm_b32 v120, v153, v152, s46
    v_perm_b32 v121, v153, v152, s47
    v_perm_b32 v122, v155, v154, s46
    v_perm_b32 v123, v155, v154, s47
    v_perm_b32 v124, v157, v156, s46
    v_perm_b32 v125, v157, v156, s47
    v_perm_b32 v126, v159, v158, s46
    v_perm_b32 v127, v159, v158, s47
L_poll_a:
    s_mov_b64 exec, s[92:93]
    s_mov_b64 s[96:97], s[92:93]
    global_load_dwordx4 v[80:83], v54, s[38:39] sc1
    global_load_dwordx4 v[84:87], v54, s[38:39] offset:16 sc1
    global_load_dwordx4 v[88:91], v55, s[38:39] sc1
    s_waitcnt vmcnt(3)
    s_mov_b64 exec, s[94:95]
    v_xor_b32 v40, v6, v65
    v_xor_b32 v41, v6, v67
    v_or_b32 v40, v40, v41
    v_xor_b32 v41, v6, v69
    v_xor_b32 v42, v6, v71
    v_or3_b32 v40, v40, v41, v42
    v_xor_b32 v41, v6, v73
    v_xor_b32 v42, v6, v75
    v_or3_b32 v40, v40, v41, v42
    v_cmp_ne_u32 vcc, 0, v40
    s_andn2_b64 s[100:101], s[94:95], vcc
    s_mov_b64 exec, s[100:101]
    v_mov_b32 v24, v64
    v_mov_b32 v25, v65
    v_mov_b32 v26, v66
    v_mov_b32 v27, v67
    v_mov_b32 v28, v68
    v_mov_b32 v29, v69
    v_mov_b32 v30, v70
    v_mov_b32 v31, v71
    v_mov_b32 v32, v72
    v_mov_b32 v33, v73
    v_mov_b32 v34, v74
    v_mov_b32 v35, v75
    s_andn2_b64 s[92:93], s[92:93], s[100:101]
    s_cbranch_scc0 L_poll_a_done
    s_mov_b64 exec, s[92:93]
    s_mov_b64 s[94:95], s[92:93]
    global_load_dwordx4 v[64:67], v54, s[38:39] sc1
    global_load_dwordx4 v[68:71], v54, s[38:39] offset:16 sc1
    global_load_dwordx4 v[72:75], v55, s[38:39] sc1
    s_waitcnt vmcnt(3)
    s_mov_b64 exec, s[96:97]
    v_xor_b32 v40, v6, v81
    v_xor_b32 v41, v6, v83
    v_or_b32 v40, v40, v41
    v_xor_b32 v41, v6, v85
    v_xor_b32 v42, v6, v87
    v_or3_b32 v40, v40, v41, v42
    v_xor_b32 v41, v6, v89
    v_xor_b32 v42, v6, v91
    v_or3_b32 v40, v40, v41, v42
    v_cmp_ne_u32 vcc, 0, v40
    s_andn2_b64 s[100:101], s[96:97], vcc
    s_mov_b64 exec, s[100:101]
    v_mov_b32 v24, v80
    v_mov_b32 v25, v81
    v_mov_b32 v26, v82
    v_mov_b32 v27, v83
    v_mov_b32 v28, v84
    v_mov_b32 v29, v85
    v_mov_b32 v30, v86
    v_mov_b32 v31, v87
    v_mov_b32 v32, v88
    v_mov_b32 v33, v89
    v_mov_b32 v34, v90
    v_mov_b32 v35, v91
    s_andn2_b64 s[92:93], s[92:93], s[100:101]
    s_cbranch_scc0 L_poll_a_done
    s_cmp_lg_u64 s[92:93], s[98:99]
    s_cbranch_scc1 L_poll_a_nosl
    s_sleep 16
L_poll_a_nosl:
    s_add_u32 s7, s7, 1
    s_cmp_lt_u32 s7, 400000
    s_cbranch_scc1 L_poll_a
    s_endpgm
L_poll_a_done:
    s_mov_b64 exec, s[98:99]
    v_mov_b32 v36, v32
    s_nop 1
    v_max_f32_dpp v36, v36, v36 row_ror:1 row_mask:0xf bank_mask:0xf
    s_nop 1
    v_max_f32_dpp v36, v36, v36 row_ror:2 row_mask:0xf bank_mask:0xf
    s_nop 1
    v_max_f32_dpp v36, v36, v36 row_ror:4 row_mask:0xf bank_mask:0xf
    s_nop 1
    v_max_f32_dpp v36, v36, v36 row_ror:8 row_mask:0xf bank_mask:0xf
    v_mov_b32 v37, v36
    s_nop 1
    v_permlane16_swap_b32 v36, v37
    v_max_f32 v36, v36, v37
    v_mov_b32 v37, v36
    s_nop 1
    v_permlane32_swap_b32 v36, v37
    v_max_f32 v36, v36, v37
    v_sub_f32 v38, v32, v36
    v_mul_f32 v38, s50, v38
    v_exp_f32 v38, v38
    v_lshlrev_b32 v40, 2, v52
    v_mul_f32 v39, v38, v34
    ds_bpermute_b32 v41, v40, v38
    s_nop 1
    v_add_f32_dpp v39, v39, v39 row_ror:1 row_mask:0xf bank_mask:0xf
    s_nop 1
    v_add_f32_dpp v39, v39, v39 row_ror:2 row_mask:0xf bank_mask:0xf
    s_nop 1
    v_add_f32_dpp v39, v39, v39 row_ror:4 row_mask:0xf bank_mask:0xf
    s_nop 1
    v_add_f32_dpp v39, v39, v39 row_ror:8 row_mask:0xf bank_mask:0xf
    v_mov_b32 v37, v39
    s_nop 1
    v_permlane16_swap_b32 v39, v37
    v_add_f32 v39, v39, v37
    s_waitcnt lgkmcnt(0)
    v_mul_f32 v24, v41, v24
    v_mul_f32 v26, v41, v26
    v_mul_f32 v28, v41, v28
    v_mul_f32 v30, v41, v30
    s_nop 1
    v_add_f32_dpp v24, v24, v24 row_ror:8 row_mask:0xf bank_mask:0xf
    v_add_f32_dpp v26, v26, v26 row_ror:8 row_mask:0xf bank_mask:0xf
    v_add_f32_dpp v28, v28, v28 row_ror:8 row_mask:0xf bank_mask:0xf
    v_add_f32_dpp v30, v30, v30 row_ror:8 row_mask:0xf bank_mask:0xf
    v_mov_b32 v25, v24
    v_mov_b32 v27, v26
    v_mov_b32 v29, v28
    v_mov_b32 v31, v30
    s_nop 1
    v_permlane16_swap_b32 v24, v25
    v_permlane16_swap_b32 v26, v27
    v_permlane16_swap_b32 v28, v29
    v_permlane16_swap_b32 v30, v31
    v_add_f32 v24, v24, v25
    v_add_f32 v26, v26, v27
    v_add_f32 v28, v28, v29
    v_add_f32 v30, v30, v31
    v_mov_b32 v25, v24
    v_mov_b32 v27, v26
    v_mov_b32 v29, v28
    v_mov_b32 v31, v30
    s_nop 1
    v_permlane32_swap_b32 v24, v25
    v_permlane32_swap_b32 v26, v27
    v_permlane32_swap_b32 v28, v29
    v_permlane32_swap_b32 v30, v31
    v_add_f32 v32, v24, v25
    v_add_f32 v33, v26, v27
    v_add_f32 v34, v28, v29
    v_add_f32 v35, v30, v31
    s_lshl_b32 s13, s3, 7
    v_lshlrev_b32 v16, 4, v1
    v_add_u32 v16, s13, v16
    s_mov_b64 exec, 0xff
    ds_write_b128 v16, v[32:35] offset:2048
    s_mov_b64 exec, -1
    v_rcp_f32 v39, v39
    s_waitcnt lgkmcnt(0)
    s_barrier
    v_and_b32 v16, 31, v1
    v_lshlrev_b32 v16, 2, v16
    ds_read_b32 v24, v16 offset:2048
    ds_read_b32 v25, v16 offset:2176
    ds_read_b32 v26, v16 offset:2304
    ds_read_b32 v27, v16 offset:2432
    s_mul_i32 s13, s2, 3584
    s_add_u32 s13, s13, 1310720
    v_lshlrev_b32 v16, 4, v0
    v_add_u32 v16, s13, v16
    s_waitcnt lgkmcnt(0)
    v_add_f32 v24, v24, v25
    v_add_f32 v24, v24, v26
    v_add_f32 v24, v24, v27
    v_mul_f32 v24, v24, v39
    s_nop 1
    v_mov_b32_dpp v25, v24 row_shl:1 row_mask:0xf bank_mask:0xf
    s_nop 0
    v_cvt_pk_bf16_f32 v28, v24, v25
    v_mov_b32 v24, 0
    v_mov_b32 v26, 0
    v_readlane_b32 s60, v28, 0
    v_readlane_b32 s61, v28, 2
    v_readlane_b32 s62, v28, 4
    v_readlane_b32 s63, v28, 6
    v_readlane_b32 s64, v28, 8
    v_readlane_b32 s65, v28, 10
    v_readlane_b32 s66, v28, 12
    v_readlane_b32 s67, v28, 14
    v_readlane_b32 s68, v28, 16
    v_readlane_b32 s69, v28, 18
    v_readlane_b32 s70, v28, 20
    v_readlane_b32 s71, v28, 22
    v_readlane_b32 s72, v28, 24
    v_readlane_b32 s73, v28, 26
    v_readlane_b32 s74, v28, 28
    v_readlane_b32 s75, v28, 30
    s_nop 1
    v_dot2_f32_bf16 v24, s60, v96, v24
    v_dot2_f32_bf16 v26, s60, v97, v26
    v_dot2_f32_bf16 v24, s61, v98, v24
    v_dot2_f32_bf16 v26, s61, v99, v26
    v_dot2_f32_bf16 v24, s62, v100, v24
    v_dot2_f32_bf16 v26, s62, v101, v26
    v_dot2_f32_bf16 v24, s63, v102, v24
    v_dot2_f32_bf16 v26, s63, v103, v26
    v_dot2_f32_bf16 v24, s64, v104, v24
    v_dot2_f32_bf16 v26, s64, v105, v26
    v_dot2_f32_bf16 v24, s65, v106, v24
    v_dot2_f32_bf16 v26, s65, v107, v26
    v_dot2_f32_bf16 v24, s66, v108, v24
    v_dot2_f32_bf16 v26, s66, v109, v26
    v_dot2_f32_bf16 v24, s67, v110, v24
    v_dot2_f32_bf16 v26, s67, v111, v26
    v_dot2_f32_bf16 v24, s68, v112, v24
    v_dot2_f32_bf16 v26, s68, v113, v26
    v_dot2_f32_bf16 v24, s69, v114, v24
    v_dot2_f32_bf16 v26, s69, v115, v26
    v_dot2_f32_bf16 v24, s70, v116, v24
    v_dot2_f32_bf16 v26, s70, v117, v26
    v_dot2_f32_bf16 v24, s71, v118, v24
    v_dot2_f32_bf16 v26, s71, v119, v26
    v_dot2_f32_bf16 v24, s72, v120, v24
    v_dot2_f32_bf16 v26, s72, v121, v26
    v_dot2_f32_bf16 v24, s73, v122, v24
    v_dot2_f32_bf16 v26, s73, v123, v26
    v_dot2_f32_bf16 v24, s74, v124, v24
    v_dot2_f32_bf16 v26, s74, v125, v26
    v_dot2_f32_bf16 v24, s75, v126, v24
    v_dot2_f32_bf16 v26, s75, v127, v26
    v_mov_b32 v25, v6
    v_mov_b32 v27, v6
    s_nop 3
    s_mov_b64 exec, s[54:55]
    global_store_dwordx4 v16, v[24:27], s[38:39] sc1
    s_mov_b64 exec, -1
    s_cmp_lg_u32 s3, 0
    s_cbranch_scc1 L_END
    s_cmp_ge_u32 s2, 112
    s_cbranch_scc1 L_END
    s_lshl_b32 s13, s2, 5
    s_add_u32 s13, s13, 1310720
    v_mul_u32_u24 v16, 3584, v1
    v_add_u32 v16, s13, v16
    v_add_u32 v17, 229376, v16
    s_mov_b64 s[98:99], exec
    s_mov_b64 s[92:93], exec
    s_mov_b64 s[94:95], exec
    global_load_dwordx4 v[64:67], v16, s[38:39] sc1
    global_load_dwordx4 v[68:71], v16, s[38:39] offset:16 sc1
    global_load_dwordx4 v[72:75], v17, s[38:39] sc1
    global_load_dwordx4 v[76:79], v17, s[38:39] offset:16 sc1
L_poll_b:
    s_mov_b64 exec, s[92:93]
    s_mov_b64 s[96:97], s[92:93]
    global_load_dwordx4 v[80:83], v16, s[38:39] sc1
    global_load_dwordx4 v[84:87], v16, s[38:39] offset:16 sc1
    global_load_dwordx4 v[88:91], v17, s[38:39] sc1
    global_load_dwordx4 v[92:95], v17, s[38:39] offset:16 sc1
    s_waitcnt vmcnt(4)
    s_mov_b64 exec, s[94:95]
    v_xor_b32 v40, v6, v65
    v_xor_b32 v41, v6, v67
    v_or_b32 v40, v40, v41
    v_xor_b32 v41, v6, v69
    v_xor_b32 v42, v6, v71
    v_or3_b32 v40, v40, v41, v42
    v_xor_b32 v41, v6, v73
    v_xor_b32 v42, v6, v75
    v_or3_b32 v40, v40, v41, v42
    v_xor_b32 v41, v6, v77
    v_xor_b32 v42, v6, v79
    v_or3_b32 v40, v40, v41, v42
    v_cmp_ne_u32 vcc, 0, v40
    s_andn2_b64 s[100:101], s[94:95], vcc
    s_mov_b64 exec, s[100:101]
    v_mov_b32 v24, v64
    v_mov_b32 v25, v65
    v_mov_b32 v26, v66
    v_mov_b32 v27, v67
    v_mov_b32 v28, v68
    v_mov_b32 v29, v69
    v_mov_b32 v30, v70
    v_mov_b32 v31, v71
    v_mov_b32 v32, v72
    v_mov_b32 v33, v73
    v_mov_b32 v34, v74
    v_mov_b32 v35, v75
    v_mov_b32 v36, v76
    v_mov_b32 v37, v77
    v_mov_b32 v38, v78
    v_mov_b32 v39, v79
    s_andn2_b64 s[92:93], s[92:93], s[100:101]
    s_cbranch_scc0 L_poll_b_done
    s_mov_b64 exec, s[92:93]
    s_mov_b64 s[94:95], s[92:93]
    global_load_dwordx4 v[64:67], v16, s[38:39] sc1
    global_load_dwordx4 v[68:71], v16, s[38:39] offset:16 sc1
    global_load_dwordx4 v[72:75], v17, s[38:39] sc1
    global_load_dwordx4 v[76:79], v17, s[38:39] offset:16 sc1
    s_waitcnt vmcnt(4)
    s_mov_b64 exec, s[96:97]
    v_xor_b32 v40, v6, v81
    v_xor_b32 v41, v6, v83
    v_or_b32 v40, v40, v41
    v_xor_b32 v41, v6, v85
    v_xor_b32 v42, v6, v87
    v_or3_b32 v40, v40, v41, v42
    v_xor_b32 v41, v6, v89
    v_xor_b32 v42, v6, v91
    v_or3_b32 v40, v40, v41, v42
    v_xor_b32 v41, v6, v93
    v_xor_b32 v42, v6, v95
    v_or3_b32 v40, v40, v41, v42
    v_cmp_ne_u32 vcc, 0, v40
    s_andn2_b64 s[100:101], s[96:97], vcc
    s_mov_b64 exec, s[100:101]
    v_mov_b32 v24, v80
    v_mov_b32 v25, v81
    v_mov_b32 v26, v82
    v_mov_b32 v27, v83
    v_mov_b32 v28, v84
    v_mov_b32 v29, v85
    v_mov_b32 v30, v86
    v_mov_b32 v31, v87
    v_mov_b32 v32, v88
    v_mov_b32 v33, v89
    v_mov_b32 v34, v90
    v_mov_b32 v35, v91
    v_mov_b32 v36, v92
    v_mov_b32 v37, v93
    v_mov_b32 v38, v94
    v_mov_b32 v39, v95
    s_andn2_b64 s[92:93], s[92:93], s[100:101]
    s_cbranch_scc0 L_poll_b_done
    s_cmp_lg_u64 s[92:93], s[98:99]
    s_cbranch_scc1 L_poll_b_nosl
    s_sleep 16
L_poll_b_nosl:
    s_add_u32 s7, s7, 1
    s_cmp_lt_u32 s7, 400000
    s_cbranch_scc1 L_poll_b
    s_endpgm
L_poll_b_done:
    s_mov_b64 exec, s[98:99]
    v_add_f32 v24, v24, v32
    v_add_f32 v26, v26, v34
    v_add_f32 v28, v28, v36
    v_add_f32 v30, v30, v38
    s_nop 1
    v_add_f32_dpp v24, v24, v24 row_ror:1 row_mask:0xf bank_mask:0xf
    v_add_f32_dpp v26, v26, v26 row_ror:1 row_mask:0xf bank_mask:0xf
    v_add_f32_dpp v28, v28, v28 row_ror:1 row_mask:0xf bank_mask:0xf
    v_add_f32_dpp v30, v30, v30 row_ror:1 row_mask:0xf bank_mask:0xf
    s_nop 1
    v_add_f32_dpp v24, v24, v24 row_ror:2 row_mask:0xf bank_mask:0xf
    v_add_f32_dpp v26, v26, v26 row_ror:2 row_mask:0xf bank_mask:0xf
    v_add_f32_dpp v28, v28, v28 row_ror:2 row_mask:0xf bank_mask:0xf
    v_add_f32_dpp v30, v30, v30 row_ror:2 row_mask:0xf bank_mask:0xf
    s_nop 1
    v_add_f32_dpp v24, v24, v24 row_ror:4 row_mask:0xf bank_mask:0xf
    v_add_f32_dpp v26, v26, v26 row_ror:4 row_mask:0xf bank_mask:0xf
    v_add_f32_dpp v28, v28, v28 row_ror:4 row_mask:0xf bank_mask:0xf
    v_add_f32_dpp v30, v30, v30 row_ror:4 row_mask:0xf bank_mask:0xf
    s_nop 1
    v_add_f32_dpp v24, v24, v24 row_ror:8 row_mask:0xf bank_mask:0xf
    v_add_f32_dpp v26, v26, v26 row_ror:8 row_mask:0xf bank_mask:0xf
    v_add_f32_dpp v28, v28, v28 row_ror:8 row_mask:0xf bank_mask:0xf
    v_add_f32_dpp v30, v30, v30 row_ror:8 row_mask:0xf bank_mask:0xf
    v_mov_b32 v25, v24
    v_mov_b32 v27, v26
    v_mov_b32 v29, v28
    v_mov_b32 v31, v30
    s_nop 1
    v_permlane16_swap_b32 v24, v25
    v_permlane16_swap_b32 v26, v27
    v_permlane16_swap_b32 v28, v29
    v_permlane16_swap_b32 v30, v31
    v_add_f32 v24, v24, v25
    v_add_f32 v26, v26, v27
    v_add_f32 v28, v28, v29
    v_add_f32 v30, v30, v31
    v_mov_b32 v25, v24
    v_mov_b32 v27, v26
    v_mov_b32 v29, v28
    v_mov_b32 v31, v30
    s_nop 1
    v_permlane32_swap_b32 v24, v25
    v_permlane32_swap_b32 v26, v27
    v_permlane32_swap_b32 v28, v29
    v_permlane32_swap_b32 v30, v31
    v_add_f32 v24, v24, v25
    v_add_f32 v26, v26, v27
    v_add_f32 v28, v28, v29
    v_add_f32 v30, v30, v31
    v_cvt_pk_bf16_f32 v32, v24, v26
    v_cvt_pk_bf16_f32 v33, v28, v30
    v_lshlrev_b32 v24, 16, v32
    v_and_b32 v25, 0xffff0000, v32
    v_lshlrev_b32 v28, 16, v62
    v_and_b32 v29, 0xffff0000, v62
    v_add_f32 v24, v24, v28
    v_add_f32 v25, v25, v29
    v_cvt_pk_bf16_f32 v248, v24, v25
    v_mov_b32 v249, v6
    v_lshlrev_b32 v24, 16, v33
    v_and_b32 v25, 0xffff0000, v33
    v_lshlrev_b32 v28, 16, v63
    v_and_b32 v29, 0xffff0000, v63
    v_add_f32 v24, v24, v28
    v_add_f32 v25, v25, v29
    v_cvt_pk_bf16_f32 v250, v24, v25
    v_mov_b32 v251, v6
    s_lshl_b32 s13, s2, 4
    s_add_u32 s13, s13, 147456
    v_lshlrev_b32 v16, 11, v1
    v_add_u32 v16, s13, v16
    s_mov_b64 exec, 65535
    global_store_dwordx4 v16, v[248:251], s[38:39] sc1
    s_mov_b64 exec, -1
    s_lshl_b32 s13, s2, 5
    s_add_u32 s13, s13, 2359296
    v_mul_u32_u24 v16, 3584, v1
    v_add_u32 v16, s13, v16
    v_mov_b32 v24, 0
    v_mov_b32 v26, 0
    v_mov_b32 v28, 0
    v_mov_b32 v30, 0
    s_mov_b64 exec, s[56:57]
    s_mov_b64 s[98:99], exec
    s_mov_b64 s[92:93], exec
    s_mov_b64 s[94:95], exec
    global_load_dwordx4 v[64:67], v16, s[38:39] sc1
    global_load_dwordx4 v[68:71], v16, s[38:39] offset:16 sc1
L_poll_d:
    s_mov_b64 exec, s[92:93]
    s_mov_b64 s[96:97], s[92:93]
    global_load_dwordx4 v[80:83], v16, s[38:39] sc1
    global_load_dwordx4 v[84:87], v16, s[38:39] offset:16 sc1
    s_waitcnt vmcnt(2)
    s_mov_b64 exec, s[94:95]
    v_xor_b32 v40, v6, v65
    v_xor_b32 v41, v6, v67
    v_or_b32 v40, v40, v41
    v_xor_b32 v41, v6, v69
    v_xor_b32 v42, v6, v71
    v_or3_b32 v40, v40, v41, v42
    v_cmp_ne_u32 vcc, 0, v40
    s_andn2_b64 s[100:101], s[94:95], vcc
    s_mov_b64 exec, s[100:101]
    v_mov_b32 v24, v64
    v_mov_b32 v25, v65
    v_mov_b32 v26, v66
    v_mov_b32 v27, v67
    v_mov_b32 v28, v68
    v_mov_b32 v29, v69
    v_mov_b32 v30, v70
    v_mov_b32 v31, v71
    s_andn2_b64 s[92:93], s[92:93], s[100:101]
    s_cbranch_scc0 L_poll_d_done
    s_mov_b64 exec, s[92:93]
    s_mov_b64 s[94:95], s[92:93]
    global_load_dwordx4 v[64:67], v16, s[38:39] sc1
    global_load_dwordx4 v[68:71], v16, s[38:39] offset:16 sc1
    s_waitcnt vmcnt(2)
    s_mov_b64 exec, s[96:97]
    v_xor_b32 v40, v6, v81
    v_xor_b32 v41, v6, v83
    v_or_b32 v40, v40, v41
    v_xor_b32 v41, v6, v85
    v_xor_b32 v42, v6, v87
    v_or3_b32 v40, v40, v41, v42
    v_cmp_ne_u32 vcc, 0, v40
    s_andn2_b64 s[100:101], s[96:97], vcc
    s_mov_b64 exec, s[100:101]
    v_mov_b32 v24, v80
    v_mov_b32 v25, v81
    v_mov_b32 v26, v82
    v_mov_b32 v27, v83
    v_mov_b32 v28, v84
    v_mov_b32 v29, v85
    v_mov_b32 v30, v86
    v_mov_b32 v31, v87
    s_andn2_b64 s[92:93], s[92:93], s[100:101]
    s_cbranch_scc0 L_poll_d_done
    s_cmp_lg_u64 s[92:93], s[98:99]
    s_cbranch_scc1 L_poll_d_nosl
    s_sleep 16
L_poll_d_nosl:
    s_add_u32 s7, s7, 1
    s_cmp_lt_u32 s7, 400000
    s_cbranch_scc1 L_poll_d
    s_endpgm
L_poll_d_done:
    s_mov_b64 exec, s[98:99]
    s_mov_b64 exec, -1
    s_nop 1
    v_add_f32_dpp v24, v24, v24 row_ror:1 row_mask:0xf bank_mask:0xf
    v_add_f32_dpp v26, v26, v26 row_ror:1 row_mask:0xf bank_mask:0xf
    v_add_f32_dpp v28, v28, v28 row_ror:1 row_mask:0xf bank_mask:0xf
    v_add_f32_dpp v30, v30, v30 row_ror:1 row_mask:0xf bank_mask:0xf
    s_nop 1
    v_add_f32_dpp v24, v24, v24 row_ror:2 row_mask:0xf bank_mask:0xf
    v_add_f32_dpp v26, v26, v26 row_ror:2 row_mask:0xf bank_mask:0xf
    v_add_f32_dpp v28, v28, v28 row_ror:2 row_mask:0xf bank_mask:0xf
    v_add_f32_dpp v30, v30, v30 row_ror:2 row_mask:0xf bank_mask:0xf
    s_nop 1
    v_add_f32_dpp v24, v24, v24 row_ror:4 row_mask:0xf bank_mask:0xf
    v_add_f32_dpp v26, v26, v26 row_ror:4 row_mask:0xf bank_mask:0xf
    v_add_f32_dpp v28, v28, v28 row_ror:4 row_mask:0xf bank_mask:0xf
    v_add_f32_dpp v30, v30, v30 row_ror:4 row_mask:0xf bank_mask:0xf
    s_nop 1
    v_add_f32_dpp v24, v24, v24 row_ror:8 row_mask:0xf bank_mask:0xf
    v_add_f32_dpp v26, v26, v26 row_ror:8 row_mask:0xf bank_mask:0xf
    v_add_f32_dpp v28, v28, v28 row_ror:8 row_mask:0xf bank_mask:0xf
    v_add_f32_dpp v30, v30, v30 row_ror:8 row_mask:0xf bank_mask:0xf
    v_mov_b32 v25, v24
    v_mov_b32 v27, v26
    v_mov_b32 v29, v28
    v_mov_b32 v31, v30
    s_nop 1
    v_permlane16_swap_b32 v24, v25
    v_permlane16_swap_b32 v26, v27
    v_permlane16_swap_b32 v28, v29
    v_permlane16_swap_b32 v30, v31
    v_add_f32 v24, v24, v25
    v_add_f32 v26, v26, v27
    v_add_f32 v28, v28, v29
    v_add_f32 v30, v30, v31
    v_mov_b32 v25, v24
    v_mov_b32 v27, v26
    v_mov_b32 v29, v28
    v_mov_b32 v31, v30
    s_nop 1
    v_permlane32_swap_b32 v24, v25
    v_permlane32_swap_b32 v26, v27
    v_permlane32_swap_b32 v28, v29
    v_permlane32_swap_b32 v30, v31
    v_add_f32 v24, v24, v25
    v_add_f32 v26, v26, v27
    v_add_f32 v28, v28, v29
    v_add_f32 v30, v30, v31
    v_cvt_pk_bf16_f32 v32, v24, v26
    v_cvt_pk_bf16_f32 v33, v28, v30
    v_lshlrev_b32 v24, 16, v32
    v_and_b32 v25, 0xffff0000, v32
    v_lshlrev_b32 v28, 16, v248
    v_and_b32 v29, 0xffff0000, v248
    v_add_f32 v24, v24, v28
    v_add_f32 v25, v25, v29
    v_cvt_pk_bf16_f32 v34, v24, v25
    v_lshlrev_b32 v24, 16, v33
    v_and_b32 v25, 0xffff0000, v33
    v_lshlrev_b32 v28, 16, v250
    v_and_b32 v29, 0xffff0000, v250
    v_add_f32 v24, v24, v28
    v_add_f32 v25, v25, v29
    v_cvt_pk_bf16_f32 v35, v24, v25
    s_lshl_b32 s13, s2, 3
    v_mov_b32 v16, s13
    s_mov_b64 exec, 1
    global_store_dwordx2 v16, v[34:35], s[34:35]
    s_cmp_lg_u32 s2, 0
    s_cbranch_scc1 L_END
    v_mov_b32 v16, 0
    global_store_dword v16, v6, s[38:39] sc1
    s_branch L_END
L_NOTA:
    s_cmp_ge_u32 s2, 184
    s_cbranch_scc1 L_END
    s_lshl_b32 s13, s2, 2
    s_add_u32 s13, s13, s3
    s_and_b32 s13, s13, 15
    s_lshl_b32 s13, s13, 11
    s_add_u32 s13, s13, 147456
    v_lshlrev_b32 v16, 5, v1
    v_add_u32 v16, s13, v16
    v_mov_b32 v24, 0
    v_mov_b32 v25, 0
    v_mov_b32 v26, 0
    v_mov_b32 v27, 0
    v_mov_b32 v28, 0
    v_mov_b32 v29, 0
    v_mov_b32 v30, 0
    v_mov_b32 v31, 0
    s_mov_b64 exec, s[56:57]
    s_mov_b64 s[98:99], exec
    s_mov_b64 s[92:93], exec
    s_mov_b64 s[94:95], exec
    global_load_dwordx4 v[64:67], v16, s[38:39] sc1
    global_load_dwordx4 v[68:71], v16, s[38:39] offset:16 sc1
    s_mov_b64 exec, -1
    s_barrier
    v_lshlrev_b32 v17, 2, v0
    v_add_u32 v17, 75520, v17
    ds_read_b32 v128, v17 offset:0
    ds_read_b32 v129, v17 offset:896
    ds_read_b32 v130, v17 offset:1792
    ds_read_b32 v131, v17 offset:2688
    ds_read_b32 v132, v17 offset:3584
    ds_read_b32 v133, v17 offset:4480
    ds_read_b32 v134, v17 offset:5376
    ds_read_b32 v135, v17 offset:6272
    s_waitcnt lgkmcnt(0)
    ds_read_b32 v136, v17 offset:7168
    ds_read_b32 v137, v17 offset:8064
    ds_read_b32 v138, v17 offset:8960
    ds_read_b32 v139, v17 offset:9856
    ds_read_b32 v140, v17 offset:10752
    ds_read_b32 v141, v17 offset:11648
    ds_read_b32 v142, v17 offset:12544
    ds_read_b32 v143, v17 offset:13440
    s_waitcnt lgkmcnt(0)
    ds_read_b32 v144, v17 offset:14336
    ds_read_b32 v145, v17 offset:15232
    ds_read_b32 v146, v17 offset:16128
    ds_read_b32 v147, v17 offset:17024
    ds_read_b32 v148, v17 offset:17920
    ds_read_b32 v149, v17 offset:18816
    ds_read_b32 v150, v17 offset:19712
    ds_read_b32 v151, v17 offset:20608
    s_waitcnt lgkmcnt(0)
    ds_read_b32 v152, v17 offset:21504
    ds_read_b32 v153, v17 offset:22400
    ds_read_b32 v154, v17 offset:23296
    ds_read_b32 v155, v17 offset:24192
    ds_read_b32 v156, v17 offset:25088
    ds_read_b32 v157, v17 offset:25984
    ds_read_b32 v158, v17 offset:26880
    ds_read_b32 v159, v17 offset:27776
    s_waitcnt lgkmcnt(0)
    v_perm_b32 v96, v129, v128, s46
    v_perm_b32 v97, v129, v128, s47
    v_perm_b32 v98, v131, v130, s46
    v_perm_b32 v99, v131, v130, s47
    v_perm_b32 v100, v133, v132, s46
    v_perm_b32 v101, v133, v132, s47
    v_perm_b32 v102, v135, v134, s46
    v_perm_b32 v103, v135, v134, s47
    v_perm_b32 v104, v137, v136, s46
    v_perm_b32 v105, v137, v136, s47
    v_perm_b32 v106, v139, v138, s46
    v_perm_b32 v107, v139, v138, s47
    v_perm_b32 v108, v141, v140, s46
    v_perm_b32 v109, v141, v140, s47
    v_perm_b32 v110, v143, v142, s46
    v_perm_b32 v111, v143, v142, s47
    v_perm_b32 v112, v145, v144, s46
    v_perm_b32 v113, v145, v144, s47
    v_perm_b32 v114, v147, v146, s46
    v_perm_b32 v115, v147, v146, s47
    v_perm_b32 v116, v149, v148, s46
    v_perm_b32 v117, v149, v148, s47
    v_perm_b32 v118, v151, v150, s46
    v_perm_b32 v119, v151, v150, s47
    v_perm_b32 v120, v153, v152, s46
    v_perm_b32 v121, v153, v152, s47
    v_perm_b32 v122, v155, v154, s46
    v_perm_b32 v123, v155, v154, s47
    v_perm_b32 v124, v157, v156, s46
    v_perm_b32 v125, v157, v156, s47
    v_perm_b32 v126, v159, v158, s46
    v_perm_b32 v127, v159, v158, s47
    v_lshrrev_b32 v18, 2, v22
    v_lshl_add_u32 v18, v23, 3, v18
    v_lshlrev_b32 v18, 6, v18
    v_and_b32 v17, 1, v1
    v_lshl_add_u32 v18, v17, 3, v18
    v_and_b32 v17, 2, v1
    v_mul_u32_u24 v17, 14336, v17
    v_add_u32 v18, v18, v17
    s_lshl_b32 s13, s3, 4
    v_add_u32 v18, s13, v18
    ds_read_b64_tr_b16 v[192:193], v18 offset:18176
    ds_read_b64_tr_b16 v[194:195], v18 offset:18432
    ds_read_b64_tr_b16 v[196:197], v18 offset:20224
    ds_read_b64_tr_b16 v[198:199], v18 offset:20480
    ds_read_b64_tr_b16 v[200:201], v18 offset:22272
    ds_read_b64_tr_b16 v[202:203], v18 offset:22528
    ds_read_b64_tr_b16 v[204:205], v18 offset:24320
    ds_read_b64_tr_b16 v[206:207], v18 offset:24576
    s_waitcnt lgkmcnt(0)
    ds_read_b64_tr_b16 v[208:209], v18 offset:26368
    ds_read_b64_tr_b16 v[210:211], v18 offset:26624
    ds_read_b64_tr_b16 v[212:213], v18 offset:28416
    ds_read_b64_tr_b16 v[214:215], v18 offset:28672
    ds_read_b64_tr_b16 v[216:217], v18 offset:30464
    ds_read_b64_tr_b16 v[218:219], v18 offset:30720
    ds_read_b64_tr_b16 v[220:221], v18 offset:32512
    ds_read_b64_tr_b16 v[222:223], v18 offset:32768
    s_waitcnt lgkmcnt(0)
    ds_read_b64_tr_b16 v[224:225], v18 offset:34560
    ds_read_b64_tr_b16 v[226:227], v18 offset:34816
    ds_read_b64_tr_b16 v[228:229], v18 offset:36608
    ds_read_b64_tr_b16 v[230:231], v18 offset:36864
    ds_read_b64_tr_b16 v[232:233], v18 offset:38656
    ds_read_b64_tr_b16 v[234:235], v18 offset:38912
    ds_read_b64_tr_b16 v[236:237], v18 offset:40704
    ds_read_b64_tr_b16 v[238:239], v18 offset:40960
    s_waitcnt lgkmcnt(0)
    ds_read_b64_tr_b16 v[240:241], v18 offset:42752
    ds_read_b64_tr_b16 v[242:243], v18 offset:43008
    ds_read_b64_tr_b16 v[244:245], v18 offset:44800
    ds_read_b64_tr_b16 v[246:247], v18 offset:45056
    s_waitcnt lgkmcnt(0)
L_poll_c:
    s_mov_b64 exec, s[92:93]
    s_mov_b64 s[96:97], s[92:93]
    global_load_dwordx4 v[80:83], v16, s[38:39] sc1
    global_load_dwordx4 v[84:87], v16, s[38:39] offset:16 sc1
    s_waitcnt vmcnt(2)
    s_mov_b64 exec, s[94:95]
    v_xor_b32 v40, v6, v65
    v_xor_b32 v41, v6, v67
    v_or_b32 v40, v40, v41
    v_xor_b32 v41, v6, v69
    v_xor_b32 v42, v6, v71
    v_or3_b32 v40, v40, v41, v42
    v_cmp_ne_u32 vcc, 0, v40
    s_andn2_b64 s[100:101], s[94:95], vcc
    s_mov_b64 exec, s[100:101]
    v_mov_b32 v24, v64
    v_mov_b32 v25, v65
    v_mov_b32 v26, v66
    v_mov_b32 v27, v67
    v_mov_b32 v28, v68
    v_mov_b32 v29, v69
    v_mov_b32 v30, v70
    v_mov_b32 v31, v71
    s_andn2_b64 s[92:93], s[92:93], s[100:101]
    s_cbranch_scc0 L_poll_c_done
    s_mov_b64 exec, s[92:93]
    s_mov_b64 s[94:95], s[92:93]
    global_load_dwordx4 v[64:67], v16, s[38:39] sc1
    global_load_dwordx4 v[68:71], v16, s[38:39] offset:16 sc1
    s_waitcnt vmcnt(2)
    s_mov_b64 exec, s[96:97]
    v_xor_b32 v40, v6, v81
    v_xor_b32 v41, v6, v83
    v_or_b32 v40, v40, v41
    v_xor_b32 v41, v6, v85
    v_xor_b32 v42, v6, v87
    v_or3_b32 v40, v40, v41, v42
    v_cmp_ne_u32 vcc, 0, v40
    s_andn2_b64 s[100:101], s[96:97], vcc
    s_mov_b64 exec, s[100:101]
    v_mov_b32 v24, v80
    v_mov_b32 v25, v81
    v_mov_b32 v26, v82
    v_mov_b32 v27, v83
    v_mov_b32 v28, v84
    v_mov_b32 v29, v85
    v_mov_b32 v30, v86
    v_mov_b32 v31, v87
    s_andn2_b64 s[92:93], s[92:93], s[100:101]
    s_cbranch_scc0 L_poll_c_done
    s_cmp_lg_u64 s[92:93], s[98:99]
    s_cbranch_scc1 L_poll_c_nosl
    s_sleep 16
L_poll_c_nosl:
    s_add_u32 s7, s7, 1
    s_cmp_lt_u32 s7, 400000
    s_cbranch_scc1 L_poll_c
    s_endpgm
L_poll_c_done:
    s_mov_b64 exec, s[98:99]
    s_mov_b64 exec, -1
    v_lshlrev_b32 v32, 16, v24
    v_and_b32 v33, 0xffff0000, v24
    v_lshlrev_b32 v34, 16, v26
    v_and_b32 v35, 0xffff0000, v26
    v_lshlrev_b32 v36, 16, v28
    v_and_b32 v37, 0xffff0000, v28
    v_lshlrev_b32 v38, 16, v30
    v_and_b32 v39, 0xffff0000, v30
    v_add_f32 v40, v32, v33
    v_add_f32 v40, v40, v34
    v_add_f32 v40, v40, v35
    v_add_f32 v40, v40, v36
    v_add_f32 v40, v40, v37
    v_add_f32 v40, v40, v38
    v_add_f32 v40, v40, v39
    s_nop 1
    v_add_f32_dpp v40, v40, v40 row_ror:1 row_mask:0xf bank_mask:0xf
    s_nop 1
    v_add_f32_dpp v40, v40, v40 row_ror:2 row_mask:0xf bank_mask:0xf
    s_nop 1
    v_add_f32_dpp v40, v40, v40 row_ror:4 row_mask:0xf bank_mask:0xf
    s_nop 1
    v_add_f32_dpp v40, v40, v40 row_ror:8 row_mask:0xf bank_mask:0xf
    v_mov_b32 v41, v40
    s_nop 1
    v_permlane16_swap_b32 v40, v41
    v_add_f32 v40, v40, v41
    v_mov_b32 v41, v40
    s_nop 1
    v_permlane32_swap_b32 v40, v41
    v_add_f32 v40, v40, v41
    v_mul_f32 v42, 0x3b124925, v40
    v_mov_b32 v44, 0
    s_mov_b64 exec, s[56:57]
    v_sub_f32 v45, v32, v42
    v_fmac_f32 v44, v45, v45
    v_sub_f32 v45, v33, v42
    v_fmac_f32 v44, v45, v45
    v_sub_f32 v45, v34, v42
    v_fmac_f32 v44, v45, v45
    v_sub_f32 v45, v35, v42
    v_fmac_f32 v44, v45, v45
    v_sub_f32 v45, v36, v42
    v_fmac_f32 v44, v45, v45
    v_sub_f32 v45, v37, v42
    v_fmac_f32 v44, v45, v45
    v_sub_f32 v45, v38, v42
    v_fmac_f32 v44, v45, v45
    v_sub_f32 v45, v39, v42
    v_fmac_f32 v44, v45, v45
    s_mov_b64 exec, -1
    s_nop 1
    v_add_f32_dpp v44, v44, v44 row_ror:1 row_mask:0xf bank_mask:0xf
    s_nop 1
    v_add_f32_dpp v44, v44, v44 row_ror:2 row_mask:0xf bank_mask:0xf
    s_nop 1
    v_add_f32_dpp v44, v44, v44 row_ror:4 row_mask:0xf bank_mask:0xf
    s_nop 1
    v_add_f32_dpp v44, v44, v44 row_ror:8 row_mask:0xf bank_mask:0xf
    v_mov_b32 v41, v44
    s_nop 1
    v_permlane16_swap_b32 v44, v41
    v_add_f32 v44, v44, v41
    v_mov_b32 v41, v44
    s_nop 1
    v_permlane32_swap_b32 v44, v41
    v_add_f32 v44, v44, v41
    v_mul_f32 v44, 0x3b124925, v44
    v_cvt_pk_bf16_f32 v41, v44, v44
    v_lshlrev_b32 v44, 16, v41
    v_add_f32 v44, 0x3727c5ac, v44
    v_cvt_pk_bf16_f32 v41, v44, v44
    v_lshlrev_b32 v44, 16, v41
    v_sqrt_f32 v46, v44
    v_mov_b32 v43, v42
    v_cvt_pk_bf16_f32 v41, v43, v43
    v_lshlrev_b32 v43, 16, v41
    v_cvt_pk_bf16_f32 v41, v46, v46
    v_lshlrev_b32 v46, 16, v41
    v_rcp_f32 v47, v46
    v_sub_f32 v32, v32, v43
    v_cvt_pk_bf16_f32 v41, v32, v32
    v_lshlrev_b32 v32, 16, v41
    v_sub_f32 v33, v33, v43
    v_cvt_pk_bf16_f32 v41, v33, v33
    v_lshlrev_b32 v33, 16, v41
    v_sub_f32 v34, v34, v43
    v_cvt_pk_bf16_f32 v41, v34, v34
    v_lshlrev_b32 v34, 16, v41
    v_sub_f32 v35, v35, v43
    v_cvt_pk_bf16_f32 v41, v35, v35
    v_lshlrev_b32 v35, 16, v41
    v_sub_f32 v36, v36, v43
    v_cvt_pk_bf16_f32 v41, v36, v36
    v_lshlrev_b32 v36, 16, v41
    v_sub_f32 v37, v37, v43
    v_cvt_pk_bf16_f32 v41, v37, v37
    v_lshlrev_b32 v37, 16, v41
    v_sub_f32 v38, v38, v43
    v_cvt_pk_bf16_f32 v41, v38, v38
    v_lshlrev_b32 v38, 16, v41
    v_sub_f32 v39, v39, v43
    v_cvt_pk_bf16_f32 v41, v39, v39
    v_lshlrev_b32 v39, 16, v41
    v_mul_f32 v45, v32, v47
    v_fma_f32 v41, -v45, v46, v32
    v_fma_f32 v32, v41, v47, v45
    v_cvt_pk_bf16_f32 v41, v32, v32
    v_lshlrev_b32 v32, 16, v41
    v_mul_f32 v45, v33, v47
    v_fma_f32 v41, -v45, v46, v33
    v_fma_f32 v33, v41, v47, v45
    v_cvt_pk_bf16_f32 v41, v33, v33
    v_lshlrev_b32 v33, 16, v41
    v_mul_f32 v45, v34, v47
    v_fma_f32 v41, -v45, v46, v34
    v_fma_f32 v34, v41, v47, v45
    v_cvt_pk_bf16_f32 v41, v34, v34
    v_lshlrev_b32 v34, 16, v41
    v_mul_f32 v45, v35, v47
    v_fma_f32 v41, -v45, v46, v35
    v_fma_f32 v35, v41, v47, v45
    v_cvt_pk_bf16_f32 v41, v35, v35
    v_lshlrev_b32 v35, 16, v41
    v_mul_f32 v45, v36, v47
    v_fma_f32 v41, -v45, v46, v36
    v_fma_f32 v36, v41, v47, v45
    v_cvt_pk_bf16_f32 v41, v36, v36
    v_lshlrev_b32 v36, 16, v41
    v_mul_f32 v45, v37, v47
    v_fma_f32 v41, -v45, v46, v37
    v_fma_f32 v37, v41, v47, v45
    v_cvt_pk_bf16_f32 v41, v37, v37
    v_lshlrev_b32 v37, 16, v41
    v_mul_f32 v45, v38, v47
    v_fma_f32 v41, -v45, v46, v38
    v_fma_f32 v38, v41, v47, v45
    v_cvt_pk_bf16_f32 v41, v38, v38
    v_lshlrev_b32 v38, 16, v41
    v_mul_f32 v45, v39, v47
    v_fma_f32 v41, -v45, v46, v39
    v_fma_f32 v39, v41, v47, v45
    v_cvt_pk_bf16_f32 v41, v39, v39
    v_lshlrev_b32 v39, 16, v41
    v_cvt_pk_bf16_f32 v24, v32, v33
    v_cvt_pk_bf16_f32 v25, v34, v35
    v_cvt_pk_bf16_f32 v26, v36, v37
    v_cvt_pk_bf16_f32 v27, v38, v39
    v_lshlrev_b32 v16, 4, v1
    s_mov_b64 exec, s[56:57]
    ds_write_b128 v16, v[24:27] offset:17024
    s_mov_b64 exec, -1
    v_lshlrev_b32 v17, 4, v23
    s_waitcnt lgkmcnt(0)
    ds_read_b128 v[136:139], v17 offset:17024
    ds_read_b128 v[140:143], v17 offset:17088
    ds_read_b128 v[144:147], v17 offset:17152
    ds_read_b128 v[148:151], v17 offset:17216
    ds_read_b128 v[152:155], v17 offset:17280
    ds_read_b128 v[156:159], v17 offset:17344
    ds_read_b128 v[160:163], v17 offset:17408
    ds_read_b128 v[164:167], v17 offset:17472
    ds_read_b128 v[168:171], v17 offset:17536
    ds_read_b128 v[172:175], v17 offset:17600
    ds_read_b128 v[176:179], v17 offset:17664
    ds_read_b128 v[180:183], v17 offset:17728
    ds_read_b128 v[184:187], v17 offset:17792
    ds_read_b128 v[188:191], v17 offset:17856
    s_waitcnt lgkmcnt(13)
    v_mfma_f32_16x16x32_bf16 v[24:27], v[192:195], v[136:139], 0
    s_waitcnt lgkmcnt(12)
    v_mfma_f32_16x16x32_bf16 v[24:27], v[196:199], v[140:143], v[24:27]
    s_waitcnt lgkmcnt(11)
    v_mfma_f32_16x16x32_bf16 v[24:27], v[200:203], v[144:147], v[24:27]
    s_waitcnt lgkmcnt(10)
    v_mfma_f32_16x16x32_bf16 v[24:27], v[204:207], v[148:151], v[24:27]
    s_waitcnt lgkmcnt(9)
    v_mfma_f32_16x16x32_bf16 v[24:27], v[208:211], v[152:155], v[24:27]
    s_waitcnt lgkmcnt(8)
    v_mfma_f32_16x16x32_bf16 v[24:27], v[212:215], v[156:159], v[24:27]
    s_waitcnt lgkmcnt(7)
    v_mfma_f32_16x16x32_bf16 v[24:27], v[216:219], v[160:163], v[24:27]
    s_waitcnt lgkmcnt(6)
    v_mfma_f32_16x16x32_bf16 v[24:27], v[220:223], v[164:167], v[24:27]
    s_waitcnt lgkmcnt(5)
    v_mfma_f32_16x16x32_bf16 v[24:27], v[224:227], v[168:171], v[24:27]
    s_waitcnt lgkmcnt(4)
    v_mfma_f32_16x16x32_bf16 v[24:27], v[228:231], v[172:175], v[24:27]
    s_waitcnt lgkmcnt(3)
    v_mfma_f32_16x16x32_bf16 v[24:27], v[232:235], v[176:179], v[24:27]
    s_waitcnt lgkmcnt(2)
    v_mfma_f32_16x16x32_bf16 v[24:27], v[236:239], v[180:183], v[24:27]
    s_waitcnt lgkmcnt(1)
    v_mfma_f32_16x16x32_bf16 v[24:27], v[240:243], v[184:187], v[24:27]
    s_waitcnt lgkmcnt(0)
    v_mfma_f32_16x16x32_bf16 v[24:27], v[244:247], v[188:191], v[24:27]
    s_nop 7
    s_nop 1
    v_mov_b32 v28, v24
    v_mov_b32 v29, v25
    v_mov_b32 v30, v26
    v_mov_b32 v31, v27
    s_nop 1
    v_permlane32_swap_b32 v24, v28
    v_permlane32_swap_b32 v25, v29
    v_permlane32_swap_b32 v26, v30
    v_permlane32_swap_b32 v27, v31
    s_mov_b32 s13, 0x3d372713
    s_mov_b32 s14, 0x40135761
    v_cvt_pk_bf16_f32 v40, v24, v24
    v_lshlrev_b32 v24, 16, v40
    v_cvt_pk_bf16_f32 v40, v28, v28
    v_lshlrev_b32 v28, 16, v40
    v_cvt_pk_bf16_f32 v40, v25, v25
    v_lshlrev_b32 v25, 16, v40
    v_cvt_pk_bf16_f32 v40, v29, v29
    v_lshlrev_b32 v29, 16, v40
    v_cvt_pk_bf16_f32 v40, v26, v26
    v_lshlrev_b32 v26, 16, v40
    v_cvt_pk_bf16_f32 v40, v30, v30
    v_lshlrev_b32 v30, 16, v40
    v_cvt_pk_bf16_f32 v40, v27, v27
    v_lshlrev_b32 v27, 16, v40
    v_cvt_pk_bf16_f32 v40, v31, v31
    v_lshlrev_b32 v31, 16, v40
    v_mul_f32 v32, v24, v24
    v_mul_f32 v32, v32, v24
    v_fma_f32 v32, s13, v32, v24
    v_mul_f32 v32, s14, v32
    v_mul_f32 v33, v25, v25
    v_mul_f32 v33, v33, v25
    v_fma_f32 v33, s13, v33, v25
    v_mul_f32 v33, s14, v33
    v_mul_f32 v34, v26, v26
    v_mul_f32 v34, v34, v26
    v_fma_f32 v34, s13, v34, v26
    v_mul_f32 v34, s14, v34
    v_mul_f32 v35, v27, v27
    v_mul_f32 v35, v35, v27
    v_fma_f32 v35, s13, v35, v27
    v_mul_f32 v35, s14, v35
    v_exp_f32 v32, v32
    v_exp_f32 v33, v33
    v_exp_f32 v34, v34
    v_exp_f32 v35, v35
    v_add_f32 v32, 1.0, v32
    v_add_f32 v33, 1.0, v33
    v_add_f32 v34, 1.0, v34
    v_add_f32 v35, 1.0, v35
    v_rcp_f32 v32, v32
    v_rcp_f32 v33, v33
    v_rcp_f32 v34, v34
    v_rcp_f32 v35, v35
    v_sub_f32 v32, 1.0, v32
    v_sub_f32 v33, 1.0, v33
    v_sub_f32 v34, 1.0, v34
    v_sub_f32 v35, 1.0, v35
    v_mul_f32 v32, v24, v32
    v_cvt_pk_bf16_f32 v40, v32, v32
    v_lshlrev_b32 v32, 16, v40
    v_mul_f32 v32, v32, v28
    v_mul_f32 v33, v25, v33
    v_cvt_pk_bf16_f32 v40, v33, v33
    v_lshlrev_b32 v33, 16, v40
    v_mul_f32 v33, v33, v29
    v_mul_f32 v34, v26, v34
    v_cvt_pk_bf16_f32 v40, v34, v34
    v_lshlrev_b32 v34, 16, v40
    v_mul_f32 v34, v34, v30
    v_mul_f32 v35, v27, v35
    v_cvt_pk_bf16_f32 v40, v35, v35
    v_lshlrev_b32 v35, 16, v40
    v_mul_f32 v35, v35, v31
    v_cvt_pk_bf16_f32 v36, v32, v33
    v_cvt_pk_bf16_f32 v37, v34, v35
    v_lshrrev_b32 v16, 1, v1
    s_lshl_b32 s13, s3, 4
    v_add_u32 v16, s13, v16
    s_mov_b32 s48, 0x00010001
    s_mov_b32 s49, 0
    s_mov_b64 exec, s[48:49]
    ds_write_b64 v16, v[36:37] offset:18048
    s_mov_b64 exec, -1
    s_waitcnt lgkmcnt(0)
    s_barrier
    v_mov_b32 v16, 0
    ds_read_b128 v[32:35], v16 offset:18048
    ds_read_b128 v[36:39], v16 offset:18064
    ds_read_b128 v[40:43], v16 offset:18080
    ds_read_b128 v[44:47], v16 offset:18096
    s_sub_u32 s13, s2, 128
    s_mul_i32 s13, s13, 3584
    s_add_u32 s13, s13, 2359296
    v_lshlrev_b32 v16, 4, v0
    v_add_u32 v16, s13, v16
    v_mov_b32 v24, 0
    v_mov_b32 v26, 0
    s_waitcnt lgkmcnt(0)
    v_dot2_f32_bf16 v24, v32, v96, v24
    v_dot2_f32_bf16 v26, v32, v97, v26
    v_dot2_f32_bf16 v24, v33, v98, v24
    v_dot2_f32_bf16 v26, v33, v99, v26
    v_dot2_f32_bf16 v24, v34, v100, v24
    v_dot2_f32_bf16 v26, v34, v101, v26
    v_dot2_f32_bf16 v24, v35, v102, v24
    v_dot2_f32_bf16 v26, v35, v103, v26
    v_dot2_f32_bf16 v24, v36, v104, v24
    v_dot2_f32_bf16 v26, v36, v105, v26
    v_dot2_f32_bf16 v24, v37, v106, v24
    v_dot2_f32_bf16 v26, v37, v107, v26
    v_dot2_f32_bf16 v24, v38, v108, v24
    v_dot2_f32_bf16 v26, v38, v109, v26
    v_dot2_f32_bf16 v24, v39, v110, v24
    v_dot2_f32_bf16 v26, v39, v111, v26
    v_dot2_f32_bf16 v24, v40, v112, v24
    v_dot2_f32_bf16 v26, v40, v113, v26
    v_dot2_f32_bf16 v24, v41, v114, v24
    v_dot2_f32_bf16 v26, v41, v115, v26
    v_dot2_f32_bf16 v24, v42, v116, v24
    v_dot2_f32_bf16 v26, v42, v117, v26
    v_dot2_f32_bf16 v24, v43, v118, v24
    v_dot2_f32_bf16 v26, v43, v119, v26
    v_dot2_f32_bf16 v24, v44, v120, v24
    v_dot2_f32_bf16 v26, v44, v121, v26
    v_dot2_f32_bf16 v24, v45, v122, v24
    v_dot2_f32_bf16 v26, v45, v123, v26
    v_dot2_f32_bf16 v24, v46, v124, v24
    v_dot2_f32_bf16 v26, v46, v125, v26
    v_dot2_f32_bf16 v24, v47, v126, v24
    v_dot2_f32_bf16 v26, v47, v127, v26
    v_mov_b32 v25, v6
    v_mov_b32 v27, v6
    s_nop 3
    s_mov_b64 exec, s[54:55]
    global_store_dwordx4 v16, v[24:27], s[38:39] sc1
    s_mov_b64 exec, -1
    s_branch L_END
L_VPATH:
    v_lshlrev_b32 v21, 12, v23
    v_lshl_add_u32 v21, v22, 4, v21
    v_add_u32 v21, s11, v21
    global_load_dwordx4 v[64:67], v21, s[20:21] offset:0
    global_load_dwordx4 v[68:71], v21, s[20:21] offset:512
    global_load_dwordx4 v[72:75], v21, s[20:21] offset:1024
    global_load_dwordx4 v[76:79], v21, s[20:21] offset:1536
    global_load_dwordx4 v[80:83], v21, s[20:21] offset:2048
    global_load_dwordx4 v[84:87], v21, s[20:21] offset:2560
    global_load_dwordx4 v[88:91], v21, s[20:21] offset:3072
    global_load_dwordx4 v[92:95], v21, s[20:21] offset:3584
    s_waitcnt vmcnt(15)
    v_readfirstlane_b32 s13, v6
    s_mul_i32 s13, s13, 1664525
    s_add_u32 s6, s13, 1013904223
    v_mov_b32 v6, s6
    v_lshlrev_b32 v24, 16, v2
    v_and_b32 v25, 0xffff0000, v2
    v_lshlrev_b32 v26, 16, v3
    v_and_b32 v27, 0xffff0000, v3
    v_lshlrev_b32 v28, 16, v4
    v_and_b32 v29, 0xffff0000, v4
    v_lshlrev_b32 v30, 16, v5
    v_and_b32 v31, 0xffff0000, v5
    v_add_f32 v32, v24, v25
    v_add_f32 v32, v32, v26
    v_add_f32 v32, v32, v27
    v_add_f32 v32, v32, v28
    v_add_f32 v32, v32, v29
    v_add_f32 v32, v32, v30
    v_add_f32 v32, v32, v31
    s_nop 1
    v_add_f32_dpp v32, v32, v32 row_ror:1 row_mask:0xf bank_mask:0xf
    s_nop 1
    v_add_f32_dpp v32, v32, v32 row_ror:2 row_mask:0xf bank_mask:0xf
    s_nop 1
    v_add_f32_dpp v32, v32, v32 row_ror:4 row_mask:0xf bank_mask:0xf
    s_nop 1
    v_add_f32_dpp v32, v32, v32 row_ror:8 row_mask:0xf bank_mask:0xf
    v_mov_b32 v33, v32
    s_nop 1
    v_permlane16_swap_b32 v32, v33
    v_add_f32 v32, v32, v33
    v_mov_b32 v33, v32
    s_nop 1
    v_permlane32_swap_b32 v32, v33
    v_add_f32 v32, v32, v33
    v_mul_f32 v34, 0x3b124925, v32
    v_mov_b32 v36, 0
    s_mov_b64 exec, s[56:57]
    v_sub_f32 v37, v24, v34
    v_fmac_f32 v36, v37, v37
    v_sub_f32 v37, v25, v34
    v_fmac_f32 v36, v37, v37
    v_sub_f32 v37, v26, v34
    v_fmac_f32 v36, v37, v37
    v_sub_f32 v37, v27, v34
    v_fmac_f32 v36, v37, v37
    v_sub_f32 v37, v28, v34
    v_fmac_f32 v36, v37, v37
    v_sub_f32 v37, v29, v34
    v_fmac_f32 v36, v37, v37
    v_sub_f32 v37, v30, v34
    v_fmac_f32 v36, v37, v37
    v_sub_f32 v37, v31, v34
    v_fmac_f32 v36, v37, v37
    s_mov_b64 exec, -1
    s_nop 1
    v_add_f32_dpp v36, v36, v36 row_ror:1 row_mask:0xf bank_mask:0xf
    s_nop 1
    v_add_f32_dpp v36, v36, v36 row_ror:2 row_mask:0xf bank_mask:0xf
    s_nop 1
    v_add_f32_dpp v36, v36, v36 row_ror:4 row_mask:0xf bank_mask:0xf
    s_nop 1
    v_add_f32_dpp v36, v36, v36 row_ror:8 row_mask:0xf bank_mask:0xf
    v_mov_b32 v33, v36
    s_nop 1
    v_permlane16_swap_b32 v36, v33
    v_add_f32 v36, v36, v33
    v_mov_b32 v33, v36
    s_nop 1
    v_permlane32_swap_b32 v36, v33
    v_add_f32 v36, v36, v33
    v_mul_f32 v36, 0x3b124925, v36
    v_cvt_pk_bf16_f32 v33, v36, v36
    v_lshlrev_b32 v36, 16, v33
    v_add_f32 v36, 0x3727c5ac, v36
    v_cvt_pk_bf16_f32 v33, v36, v36
    v_lshlrev_b32 v36, 16, v33
    v_sqrt_f32 v38, v36
    v_mov_b32 v35, v34
    v_cvt_pk_bf16_f32 v33, v35, v35
    v_lshlrev_b32 v35, 16, v33
    v_cvt_pk_bf16_f32 v33, v38, v38
    v_lshlrev_b32 v38, 16, v33
    v_rcp_f32 v39, v38
    v_sub_f32 v24, v24, v35
    v_cvt_pk_bf16_f32 v33, v24, v24
    v_lshlrev_b32 v24, 16, v33
    v_sub_f32 v25, v25, v35
    v_cvt_pk_bf16_f32 v33, v25, v25
    v_lshlrev_b32 v25, 16, v33
    v_sub_f32 v26, v26, v35
    v_cvt_pk_bf16_f32 v33, v26, v26
    v_lshlrev_b32 v26, 16, v33
    v_sub_f32 v27, v27, v35
    v_cvt_pk_bf16_f32 v33, v27, v27
    v_lshlrev_b32 v27, 16, v33
    v_sub_f32 v28, v28, v35
    v_cvt_pk_bf16_f32 v33, v28, v28
    v_lshlrev_b32 v28, 16, v33
    v_sub_f32 v29, v29, v35
    v_cvt_pk_bf16_f32 v33, v29, v29
    v_lshlrev_b32 v29, 16, v33
    v_sub_f32 v30, v30, v35
    v_cvt_pk_bf16_f32 v33, v30, v30
    v_lshlrev_b32 v30, 16, v33
    v_sub_f32 v31, v31, v35
    v_cvt_pk_bf16_f32 v33, v31, v31
    v_lshlrev_b32 v31, 16, v33
    v_mul_f32 v37, v24, v39
    v_fma_f32 v33, -v37, v38, v24
    v_fma_f32 v24, v33, v39, v37
    v_cvt_pk_bf16_f32 v33, v24, v24
    v_lshlrev_b32 v24, 16, v33
    v_mul_f32 v37, v25, v39
    v_fma_f32 v33, -v37, v38, v25
    v_fma_f32 v25, v33, v39, v37
    v_cvt_pk_bf16_f32 v33, v25, v25
    v_lshlrev_b32 v25, 16, v33
    v_mul_f32 v37, v26, v39
    v_fma_f32 v33, -v37, v38, v26
    v_fma_f32 v26, v33, v39, v37
    v_cvt_pk_bf16_f32 v33, v26, v26
    v_lshlrev_b32 v26, 16, v33
    v_mul_f32 v37, v27, v39
    v_fma_f32 v33, -v37, v38, v27
    v_fma_f32 v27, v33, v39, v37
    v_cvt_pk_bf16_f32 v33, v27, v27
    v_lshlrev_b32 v27, 16, v33
    v_mul_f32 v37, v28, v39
    v_fma_f32 v33, -v37, v38, v28
    v_fma_f32 v28, v33, v39, v37
    v_cvt_pk_bf16_f32 v33, v28, v28
    v_lshlrev_b32 v28, 16, v33
    v_mul_f32 v37, v29, v39
    v_fma_f32 v33, -v37, v38, v29
    v_fma_f32 v29, v33, v39, v37
    v_cvt_pk_bf16_f32 v33, v29, v29
    v_lshlrev_b32 v29, 16, v33
    v_mul_f32 v37, v30, v39
    v_fma_f32 v33, -v37, v38, v30
    v_fma_f32 v30, v33, v39, v37
    v_cvt_pk_bf16_f32 v33, v30, v30
    v_lshlrev_b32 v30, 16, v33
    v_mul_f32 v37, v31, v39
    v_fma_f32 v33, -v37, v38, v31
    v_fma_f32 v31, v33, v39, v37
    v_cvt_pk_bf16_f32 v33, v31, v31
    v_lshlrev_b32 v31, 16, v33
    v_lshlrev_b32 v16, 5, v1
    s_mov_b64 exec, s[56:57]
    ds_write_b128 v16, v[24:27] offset:0
    ds_write_b128 v16, v[28:31] offset:16
    s_mov_b64 exec, -1
    s_mul_i32 s13, s8, 448
    v_mul_u32_u24 v16, 28, v18
    v_add_u32 v16, s13, v16
    s_waitcnt lgkmcnt(0)
    ds_read_b32 v24, v16 offset:0
    ds_read_b32 v25, v16 offset:4
    ds_read_b32 v26, v16 offset:8
    ds_read_b32 v27, v16 offset:12
    ds_read_b32 v28, v16 offset:16
    ds_read_b32 v29, v16 offset:20
    ds_read_b32 v30, v16 offset:24
    v_mov_b32 v32, 0
    v_mov_b32 v33, 0
    s_waitcnt vmcnt(8) lgkmcnt(0)
    v_lshlrev_b32 v34, 16, v8
    v_and_b32 v35, 0xffff0000, v8
    v_fmac_f32 v32, v24, v34
    v_fmac_f32 v33, v24, v35
    v_lshlrev_b32 v34, 16, v9
    v_and_b32 v35, 0xffff0000, v9
    v_fmac_f32 v32, v25, v34
    v_fmac_f32 v33, v25, v35
    v_lshlrev_b32 v34, 16, v10
    v_and_b32 v35, 0xffff0000, v10
    v_fmac_f32 v32, v26, v34
    v_fmac_f32 v33, v26, v35
    v_lshlrev_b32 v34, 16, v11
    v_and_b32 v35, 0xffff0000, v11
    v_fmac_f32 v32, v27, v34
    v_fmac_f32 v33, v27, v35
    v_lshlrev_b32 v34, 16, v12
    v_and_b32 v35, 0xffff0000, v12
    v_fmac_f32 v32, v28, v34
    v_fmac_f32 v33, v28, v35
    v_lshlrev_b32 v34, 16, v13
    v_and_b32 v35, 0xffff0000, v13
    v_fmac_f32 v32, v29, v34
    v_fmac_f32 v33, v29, v35
    v_lshlrev_b32 v34, 16, v14
    v_and_b32 v35, 0xffff0000, v14
    v_fmac_f32 v32, v30, v34
    v_fmac_f32 v33, v30, v35
    v_lshlrev_b32 v16, 8, v18
    v_lshl_add_u32 v16, v19, 3, v16
    ds_write_b64 v16, v[32:33] offset:2048
    v_mov_b32 v16, 0
    ds_write_b32 v16, v16 offset:17008
    s_waitcnt lgkmcnt(0)
    s_barrier
    s_min_u32 s13, s2, 127
    s_mul_i32 s13, s13, 28672
    v_lshlrev_b32 v56, 4, v1
    v_add_u32 v57, s13, v56
    s_mul_i32 s13, s51, 28672
    v_add_u32 v58, s13, v56
    s_lshl_b32 s13, s51, 6
    v_lshrrev_b32 v59, 2, v1
    v_mul_u32_u24 v59, 3584, v59
    v_and_b32 v60, 3, v1
    v_lshl_add_u32 v59, v60, 4, v59
    v_add_u32 v59, s13, v59
    global_load_dwordx4 v[96:99], v21, s[20:21] offset:256
    global_load_dwordx4 v[100:103], v21, s[20:21] offset:768
    global_load_dwordx4 v[104:107], v21, s[20:21] offset:1280
    global_load_dwordx4 v[108:111], v21, s[20:21] offset:1792
    global_load_dwordx4 v[112:115], v21, s[20:21] offset:2304
    global_load_dwordx4 v[116:119], v21, s[20:21] offset:2816
    global_load_dwordx4 v[120:123], v21, s[20:21] offset:3328
    global_load_dwordx4 v[124:127], v21, s[20:21] offset:3840
    v_add_u32 v21, 0x4000, v21
    global_load_dwordx4 v[128:131], v21, s[20:21] offset:0
    global_load_dwordx4 v[132:135], v21, s[20:21] offset:512
    global_load_dwordx4 v[136:139], v21, s[20:21] offset:1024
    global_load_dwordx4 v[140:143], v21, s[20:21] offset:1536
    global_load_dwordx4 v[144:147], v21, s[20:21] offset:2048
    global_load_dwordx4 v[148:151], v21, s[20:21] offset:2560
    global_load_dwordx4 v[152:155], v21, s[20:21] offset:3072
    global_load_dwordx4 v[156:159], v21, s[20:21] offset:3584
    global_load_dwordx4 v[160:163], v21, s[20:21] offset:256
    global_load_dwordx4 v[164:167], v21, s[20:21] offset:768
    global_load_dwordx4 v[168:171], v21, s[20:21] offset:1280
    global_load_dwordx4 v[172:175], v21, s[20:21] offset:1792
    global_load_dwordx4 v[176:179], v21, s[20:21] offset:2304
    global_load_dwordx4 v[180:183], v21, s[20:21] offset:2816
    global_load_dwordx4 v[184:187], v21, s[20:21] offset:3328
    global_load_dwordx4 v[188:191], v21, s[20:21] offset:3840
    s_barrier
    s_and_b32 s13, s3, 3
    s_lshl_b32 s13, s13, 8
    v_and_b32 v16, 1, v1
    v_lshlrev_b32 v16, 7, v16
    v_lshl_add_u32 v16, v23, 4, v16
    v_add_u32 v16, s13, v16
    ds_read_b128 v[8:11], v16 offset:7168
    ds_read_b128 v[12:15], v16 offset:7232
    s_waitcnt lgkmcnt(0)
    s_waitcnt vmcnt(24)
    v_perm_b32 v24, v68, v64, s46
    v_perm_b32 v25, v76, v72, s46
    v_perm_b32 v26, v84, v80, s46
    v_perm_b32 v27, v92, v88, s46
    v_perm_b32 v28, v68, v64, s47
    v_perm_b32 v29, v76, v72, s47
    v_perm_b32 v30, v84, v80, s47
    v_perm_b32 v31, v92, v88, s47
    v_perm_b32 v32, v69, v65, s46
    v_perm_b32 v33, v77, v73, s46
    v_perm_b32 v34, v85, v81, s46
    v_perm_b32 v35, v93, v89, s46
    v_perm_b32 v36, v69, v65, s47
    v_perm_b32 v37, v77, v73, s47
    v_perm_b32 v38, v85, v81, s47
    v_perm_b32 v39, v93, v89, s47
    v_perm_b32 v40, v70, v66, s46
    v_perm_b32 v41, v78, v74, s46
    v_perm_b32 v42, v86, v82, s46
    v_perm_b32 v43, v94, v90, s46
    v_perm_b32 v44, v70, v66, s47
    v_perm_b32 v45, v78, v74, s47
    v_perm_b32 v46, v86, v82, s47
    v_perm_b32 v47, v94, v90, s47
    v_perm_b32 v48, v71, v67, s46
    v_perm_b32 v49, v79, v75, s46
    v_perm_b32 v50, v87, v83, s46
    v_perm_b32 v51, v95, v91, s46
    v_perm_b32 v52, v71, v67, s47
    v_perm_b32 v53, v79, v75, s47
    v_perm_b32 v54, v87, v83, s47
    v_perm_b32 v55, v95, v91, s47
    s_nop 1
    v_mfma_f32_16x16x32_bf16 v[192:195], v[8:11], v[24:27], 0
    v_mfma_f32_16x16x32_bf16 v[196:199], v[8:11], v[28:31], 0
    v_mfma_f32_16x16x32_bf16 v[200:203], v[8:11], v[32:35], 0
    v_mfma_f32_16x16x32_bf16 v[204:207], v[8:11], v[36:39], 0
    v_mfma_f32_16x16x32_bf16 v[208:211], v[8:11], v[40:43], 0
    v_mfma_f32_16x16x32_bf16 v[212:215], v[8:11], v[44:47], 0
    v_mfma_f32_16x16x32_bf16 v[216:219], v[8:11], v[48:51], 0
    v_mfma_f32_16x16x32_bf16 v[220:223], v[8:11], v[52:55], 0
    s_nop 7
    s_waitcnt vmcnt(16)
    v_perm_b32 v24, v100, v96, s46
    v_perm_b32 v25, v108, v104, s46
    v_perm_b32 v26, v116, v112, s46
    v_perm_b32 v27, v124, v120, s46
    v_perm_b32 v28, v100, v96, s47
    v_perm_b32 v29, v108, v104, s47
    v_perm_b32 v30, v116, v112, s47
    v_perm_b32 v31, v124, v120, s47
    v_perm_b32 v32, v101, v97, s46
    v_perm_b32 v33, v109, v105, s46
    v_perm_b32 v34, v117, v113, s46
    v_perm_b32 v35, v125, v121, s46
    v_perm_b32 v36, v101, v97, s47
    v_perm_b32 v37, v109, v105, s47
    v_perm_b32 v38, v117, v113, s47
    v_perm_b32 v39, v125, v121, s47
    v_perm_b32 v40, v102, v98, s46
    v_perm_b32 v41, v110, v106, s46
    v_perm_b32 v42, v118, v114, s46
    v_perm_b32 v43, v126, v122, s46
    v_perm_b32 v44, v102, v98, s47
    v_perm_b32 v45, v110, v106, s47
    v_perm_b32 v46, v118, v114, s47
    v_perm_b32 v47, v126, v122, s47
    v_perm_b32 v48, v103, v99, s46
    v_perm_b32 v49, v111, v107, s46
    v_perm_b32 v50, v119, v115, s46
    v_perm_b32 v51, v127, v123, s46
    v_perm_b32 v52, v103, v99, s47
    v_perm_b32 v53, v111, v107, s47
    v_perm_b32 v54, v119, v115, s47
    v_perm_b32 v55, v127, v123, s47
    s_nop 1
    v_mfma_f32_16x16x32_bf16 v[224:227], v[8:11], v[24:27], 0
    v_mfma_f32_16x16x32_bf16 v[228:231], v[8:11], v[28:31], 0
    v_mfma_f32_16x16x32_bf16 v[232:235], v[8:11], v[32:35], 0
    v_mfma_f32_16x16x32_bf16 v[236:239], v[8:11], v[36:39], 0
    v_mfma_f32_16x16x32_bf16 v[240:243], v[8:11], v[40:43], 0
    v_mfma_f32_16x16x32_bf16 v[244:247], v[8:11], v[44:47], 0
    v_mfma_f32_16x16x32_bf16 v[248:251], v[8:11], v[48:51], 0
    v_mfma_f32_16x16x32_bf16 v[252:255], v[8:11], v[52:55], 0
    s_nop 7
    s_waitcnt vmcnt(8)
    v_perm_b32 v24, v132, v128, s46
    v_perm_b32 v25, v140, v136, s46
    v_perm_b32 v26, v148, v144, s46
    v_perm_b32 v27, v156, v152, s46
    v_perm_b32 v28, v132, v128, s47
    v_perm_b32 v29, v140, v136, s47
    v_perm_b32 v30, v148, v144, s47
    v_perm_b32 v31, v156, v152, s47
    v_perm_b32 v32, v133, v129, s46
    v_perm_b32 v33, v141, v137, s46
    v_perm_b32 v34, v149, v145, s46
    v_perm_b32 v35, v157, v153, s46
    v_perm_b32 v36, v133, v129, s47
    v_perm_b32 v37, v141, v137, s47
    v_perm_b32 v38, v149, v145, s47
    v_perm_b32 v39, v157, v153, s47
    v_perm_b32 v40, v134, v130, s46
    v_perm_b32 v41, v142, v138, s46
    v_perm_b32 v42, v150, v146, s46
    v_perm_b32 v43, v158, v154, s46
    v_perm_b32 v44, v134, v130, s47
    v_perm_b32 v45, v142, v138, s47
    v_perm_b32 v46, v150, v146, s47
    v_perm_b32 v47, v158, v154, s47
    v_perm_b32 v48, v135, v131, s46
    v_perm_b32 v49, v143, v139, s46
    v_perm_b32 v50, v151, v147, s46
    v_perm_b32 v51, v159, v155, s46
    v_perm_b32 v52, v135, v131, s47
    v_perm_b32 v53, v143, v139, s47
    v_perm_b32 v54, v151, v147, s47
    v_perm_b32 v55, v159, v155, s47
    s_nop 1
    v_mfma_f32_16x16x32_bf16 v[192:195], v[12:15], v[24:27], v[192:195]
    v_mfma_f32_16x16x32_bf16 v[196:199], v[12:15], v[28:31], v[196:199]
    v_mfma_f32_16x16x32_bf16 v[200:203], v[12:15], v[32:35], v[200:203]
    v_mfma_f32_16x16x32_bf16 v[204:207], v[12:15], v[36:39], v[204:207]
    v_mfma_f32_16x16x32_bf16 v[208:211], v[12:15], v[40:43], v[208:211]
    v_mfma_f32_16x16x32_bf16 v[212:215], v[12:15], v[44:47], v[212:215]
    v_mfma_f32_16x16x32_bf16 v[216:219], v[12:15], v[48:51], v[216:219]
    v_mfma_f32_16x16x32_bf16 v[220:223], v[12:15], v[52:55], v[220:223]
    s_nop 7
    s_waitcnt vmcnt(0)
    v_perm_b32 v24, v164, v160, s46
    v_perm_b32 v25, v172, v168, s46
    v_perm_b32 v26, v180, v176, s46
    v_perm_b32 v27, v188, v184, s46
    v_perm_b32 v28, v164, v160, s47
    v_perm_b32 v29, v172, v168, s47
    v_perm_b32 v30, v180, v176, s47
    v_perm_b32 v31, v188, v184, s47
    v_perm_b32 v32, v165, v161, s46
    v_perm_b32 v33, v173, v169, s46
    v_perm_b32 v34, v181, v177, s46
    v_perm_b32 v35, v189, v185, s46
    v_perm_b32 v36, v165, v161, s47
    v_perm_b32 v37, v173, v169, s47
    v_perm_b32 v38, v181, v177, s47
    v_perm_b32 v39, v189, v185, s47
    v_perm_b32 v40, v166, v162, s46
    v_perm_b32 v41, v174, v170, s46
    v_perm_b32 v42, v182, v178, s46
    v_perm_b32 v43, v190, v186, s46
    v_perm_b32 v44, v166, v162, s47
    v_perm_b32 v45, v174, v170, s47
    v_perm_b32 v46, v182, v178, s47
    v_perm_b32 v47, v190, v186, s47
    v_perm_b32 v48, v167, v163, s46
    v_perm_b32 v49, v175, v171, s46
    v_perm_b32 v50, v183, v179, s46
    v_perm_b32 v51, v191, v187, s46
    v_perm_b32 v52, v167, v163, s47
    v_perm_b32 v53, v175, v171, s47
    v_perm_b32 v54, v183, v179, s47
    v_perm_b32 v55, v191, v187, s47
    s_nop 1
    v_mfma_f32_16x16x32_bf16 v[224:227], v[12:15], v[24:27], v[224:227]
    v_mfma_f32_16x16x32_bf16 v[228:231], v[12:15], v[28:31], v[228:231]
    v_mfma_f32_16x16x32_bf16 v[232:235], v[12:15], v[32:35], v[232:235]
    v_mfma_f32_16x16x32_bf16 v[236:239], v[12:15], v[36:39], v[236:239]
    v_mfma_f32_16x16x32_bf16 v[240:243], v[12:15], v[40:43], v[240:243]
    v_mfma_f32_16x16x32_bf16 v[244:247], v[12:15], v[44:47], v[244:247]
    v_mfma_f32_16x16x32_bf16 v[248:251], v[12:15], v[48:51], v[248:251]
    v_mfma_f32_16x16x32_bf16 v[252:255], v[12:15], v[52:55], v[252:255]
    s_nop 7
    s_nop 1
    s_and_b32 s13, s3, 3
    s_lshl_b32 s13, s13, 11
    v_lshlrev_b32 v16, 5, v1
    v_add_u32 v16, s13, v16
    s_mov_b64 exec, 0xffff
    ds_write_b32 v16, v192 offset:8448
    ds_write_b32 v16, v193 offset:9472
    ds_write_b32 v16, v196 offset:8452
    ds_write_b32 v16, v197 offset:9476
    ds_write_b32 v16, v200 offset:8456
    ds_write_b32 v16, v201 offset:9480
    ds_write_b32 v16, v204 offset:8460
    ds_write_b32 v16, v205 offset:9484
    ds_write_b32 v16, v208 offset:8464
    ds_write_b32 v16, v209 offset:9488
    ds_write_b32 v16, v212 offset:8468
    ds_write_b32 v16, v213 offset:9492
    ds_write_b32 v16, v216 offset:8472
    ds_write_b32 v16, v217 offset:9496
    ds_write_b32 v16, v220 offset:8476
    ds_write_b32 v16, v221 offset:9500
    ds_write_b32 v16, v224 offset:8960
    ds_write_b32 v16, v225 offset:9984
    ds_write_b32 v16, v228 offset:8964
    ds_write_b32 v16, v229 offset:9988
    ds_write_b32 v16, v232 offset:8968
    ds_write_b32 v16, v233 offset:9992
    ds_write_b32 v16, v236 offset:8972
    ds_write_b32 v16, v237 offset:9996
    ds_write_b32 v16, v240 offset:8976
    ds_write_b32 v16, v241 offset:10000
    ds_write_b32 v16, v244 offset:8980
    ds_write_b32 v16, v245 offset:10004
    ds_write_b32 v16, v248 offset:8984
    ds_write_b32 v16, v249 offset:10008
    ds_write_b32 v16, v252 offset:8988
    ds_write_b32 v16, v253 offset:10012
    s_mov_b64 exec, -1
    s_waitcnt lgkmcnt(0)
    s_barrier
    s_cmp_ge_u32 s2, 128
    s_cbranch_scc1 L_NOWDMA
    s_barrier
    s_cmp_lg_u32 s3, 4
    s_cbranch_scc1 L_DMAw1
    s_mov_b32 m0, 18176
    v_add_u32 v60, 0, v57
    global_load_lds_dwordx4 v60, s[24:25]
    s_mov_b32 m0, 19200
    v_add_u32 v61, 1024, v57
    global_load_lds_dwordx4 v61, s[24:25]
    s_mov_b32 m0, 20224
    v_add_u32 v62, 2048, v57
    global_load_lds_dwordx4 v62, s[24:25]
    s_mov_b32 m0, 21248
    v_add_u32 v63, 3072, v57
    global_load_lds_dwordx4 v63, s[24:25]
    s_mov_b32 m0, 22272
    v_add_u32 v60, 4096, v57
    global_load_lds_dwordx4 v60, s[24:25]
    s_mov_b32 m0, 23296
    v_add_u32 v61, 5120, v57
    global_load_lds_dwordx4 v61, s[24:25]
    s_mov_b32 m0, 24320
    v_add_u32 v62, 6144, v57
    global_load_lds_dwordx4 v62, s[24:25]
    s_branch L_DMAw_DONE
L_DMAw1:
    s_cmp_lg_u32 s3, 5
    s_cbranch_scc1 L_DMAw2
    s_mov_b32 m0, 25344
    v_add_u32 v60, 7168, v57
    global_load_lds_dwordx4 v60, s[24:25]
    s_mov_b32 m0, 26368
    v_add_u32 v61, 8192, v57
    global_load_lds_dwordx4 v61, s[24:25]
    s_mov_b32 m0, 27392
    v_add_u32 v62, 9216, v57
    global_load_lds_dwordx4 v62, s[24:25]
    s_mov_b32 m0, 28416
    v_add_u32 v63, 10240, v57
    global_load_lds_dwordx4 v63, s[24:25]
    s_mov_b32 m0, 29440
    v_add_u32 v60, 11264, v57
    global_load_lds_dwordx4 v60, s[24:25]
    s_mov_b32 m0, 30464
    v_add_u32 v61, 12288, v57
    global_load_lds_dwordx4 v61, s[24:25]
    s_mov_b32 m0, 31488
    v_add_u32 v62, 13312, v57
    global_load_lds_dwordx4 v62, s[24:25]
    s_branch L_DMAw_DONE
L_DMAw2:
    s_cmp_lg_u32 s3, 6
    s_cbranch_scc1 L_DMAw3
    s_mov_b32 m0, 32512
    v_add_u32 v60, 14336, v57
    global_load_lds_dwordx4 v60, s[24:25]
    s_mov_b32 m0, 33536
    v_add_u32 v61, 15360, v57
    global_load_lds_dwordx4 v61, s[24:25]
    s_mov_b32 m0, 34560
    v_add_u32 v62, 16384, v57
    global_load_lds_dwordx4 v62, s[24:25]
    s_mov_b32 m0, 35584
    v_add_u32 v63, 17408, v57
    global_load_lds_dwordx4 v63, s[24:25]
    s_mov_b32 m0, 36608
    v_add_u32 v60, 18432, v57
    global_load_lds_dwordx4 v60, s[24:25]
    s_mov_b32 m0, 37632
    v_add_u32 v61, 19456, v57
    global_load_lds_dwordx4 v61, s[24:25]
    s_mov_b32 m0, 38656
    v_add_u32 v62, 20480, v57
    global_load_lds_dwordx4 v62, s[24:25]
    s_branch L_DMAw_DONE
L_DMAw3:
    s_mov_b32 m0, 39680
    v_add_u32 v60, 21504, v57
    global_load_lds_dwordx4 v60, s[24:25]
    s_mov_b32 m0, 40704
    v_add_u32 v61, 22528, v57
    global_load_lds_dwordx4 v61, s[24:25]
    s_mov_b32 m0, 41728
    v_add_u32 v62, 23552, v57
    global_load_lds_dwordx4 v62, s[24:25]
    s_mov_b32 m0, 42752
    v_add_u32 v63, 24576, v57
    global_load_lds_dwordx4 v63, s[24:25]
    s_mov_b32 m0, 43776
    v_add_u32 v60, 25600, v57
    global_load_lds_dwordx4 v60, s[24:25]
    s_mov_b32 m0, 44800
    v_add_u32 v61, 26624, v57
    global_load_lds_dwordx4 v61, s[24:25]
    s_mov_b32 m0, 45824
    v_add_u32 v62, 27648, v57
    global_load_lds_dwordx4 v62, s[24:25]
L_DMAw_DONE:
    s_waitcnt vmcnt(0)
    s_barrier
    s_branch L_END
L_NOWDMA:
    s_cmp_lt_u32 s2, 128
    s_cbranch_scc1 L_END
    s_cmp_ge_u32 s2, 184
    s_cbranch_scc1 L_END
    s_cmp_lg_u32 s3, 4
    s_cbranch_scc1 L_DMAf1
    s_mov_b32 m0, 18176
    v_add_u32 v60, 0, v59
    global_load_lds_dwordx4 v60, s[28:29]
    s_mov_b32 m0, 19200
    v_add_u32 v61, 57344, v59
    global_load_lds_dwordx4 v61, s[28:29]
    s_mov_b32 m0, 20224
    v_add_u32 v62, 114688, v59
    global_load_lds_dwordx4 v62, s[28:29]
    s_mov_b32 m0, 21248
    v_add_u32 v63, 172032, v59
    global_load_lds_dwordx4 v63, s[28:29]
    s_mov_b32 m0, 22272
    v_add_u32 v60, 229376, v59
    global_load_lds_dwordx4 v60, s[28:29]
    s_mov_b32 m0, 23296
    v_add_u32 v61, 286720, v59
    global_load_lds_dwordx4 v61, s[28:29]
    s_mov_b32 m0, 24320
    v_add_u32 v62, 344064, v59
    global_load_lds_dwordx4 v62, s[28:29]
    s_mov_b32 m0, 25344
    v_add_u32 v63, 401408, v59
    global_load_lds_dwordx4 v63, s[28:29]
    s_mov_b32 m0, 26368
    v_add_u32 v60, 458752, v59
    global_load_lds_dwordx4 v60, s[28:29]
    s_mov_b32 m0, 27392
    v_add_u32 v61, 516096, v59
    global_load_lds_dwordx4 v61, s[28:29]
    s_mov_b32 m0, 28416
    v_add_u32 v62, 573440, v59
    global_load_lds_dwordx4 v62, s[28:29]
    s_mov_b32 m0, 29440
    v_add_u32 v63, 630784, v59
    global_load_lds_dwordx4 v63, s[28:29]
    s_mov_b32 m0, 30464
    v_add_u32 v60, 688128, v59
    global_load_lds_dwordx4 v60, s[28:29]
    s_mov_b32 m0, 31488
    v_add_u32 v61, 745472, v59
    global_load_lds_dwordx4 v61, s[28:29]
    s_mov_b32 m0, 32512
    v_add_u32 v62, 802816, v59
    global_load_lds_dwordx4 v62, s[28:29]
    s_mov_b32 m0, 33536
    v_add_u32 v63, 860160, v59
    global_load_lds_dwordx4 v63, s[28:29]
    s_mov_b32 m0, 34560
    v_add_u32 v60, 917504, v59
    global_load_lds_dwordx4 v60, s[28:29]
    s_mov_b32 m0, 35584
    v_add_u32 v61, 974848, v59
    global_load_lds_dwordx4 v61, s[28:29]
    s_mov_b32 m0, 36608
    v_add_u32 v62, 1032192, v59
    global_load_lds_dwordx4 v62, s[28:29]
    s_mov_b32 m0, 37632
    v_add_u32 v63, 1089536, v59
    global_load_lds_dwordx4 v63, s[28:29]
    s_mov_b32 m0, 38656
    v_add_u32 v60, 1146880, v59
    global_load_lds_dwordx4 v60, s[28:29]
    s_branch L_DMAf_DONE
L_DMAf1:
    s_cmp_lg_u32 s3, 5
    s_cbranch_scc1 L_DMAf2
    s_mov_b32 m0, 39680
    v_add_u32 v60, 1204224, v59
    global_load_lds_dwordx4 v60, s[28:29]
    s_mov_b32 m0, 40704
    v_add_u32 v61, 1261568, v59
    global_load_lds_dwordx4 v61, s[28:29]
    s_mov_b32 m0, 41728
    v_add_u32 v62, 1318912, v59
    global_load_lds_dwordx4 v62, s[28:29]
    s_mov_b32 m0, 42752
    v_add_u32 v63, 1376256, v59
    global_load_lds_dwordx4 v63, s[28:29]
    s_mov_b32 m0, 43776
    v_add_u32 v60, 1433600, v59
    global_load_lds_dwordx4 v60, s[28:29]
    s_mov_b32 m0, 44800
    v_add_u32 v61, 1490944, v59
    global_load_lds_dwordx4 v61, s[28:29]
    s_mov_b32 m0, 45824
    v_add_u32 v62, 1548288, v59
    global_load_lds_dwordx4 v62, s[28:29]
    s_mov_b32 m0, 46848
    v_add_u32 v63, 0, v59
    global_load_lds_dwordx4 v63, s[30:31]
    s_mov_b32 m0, 47872
    v_add_u32 v60, 57344, v59
    global_load_lds_dwordx4 v60, s[30:31]
    s_mov_b32 m0, 48896
    v_add_u32 v61, 114688, v59
    global_load_lds_dwordx4 v61, s[30:31]
    s_mov_b32 m0, 49920
    v_add_u32 v62, 172032, v59
    global_load_lds_dwordx4 v62, s[30:31]
    s_mov_b32 m0, 50944
    v_add_u32 v63, 229376, v59
    global_load_lds_dwordx4 v63, s[30:31]
    s_mov_b32 m0, 51968
    v_add_u32 v60, 286720, v59
    global_load_lds_dwordx4 v60, s[30:31]
    s_mov_b32 m0, 52992
    v_add_u32 v61, 344064, v59
    global_load_lds_dwordx4 v61, s[30:31]
    s_mov_b32 m0, 54016
    v_add_u32 v62, 401408, v59
    global_load_lds_dwordx4 v62, s[30:31]
    s_mov_b32 m0, 55040
    v_add_u32 v63, 458752, v59
    global_load_lds_dwordx4 v63, s[30:31]
    s_mov_b32 m0, 56064
    v_add_u32 v60, 516096, v59
    global_load_lds_dwordx4 v60, s[30:31]
    s_mov_b32 m0, 57088
    v_add_u32 v61, 573440, v59
    global_load_lds_dwordx4 v61, s[30:31]
    s_mov_b32 m0, 58112
    v_add_u32 v62, 630784, v59
    global_load_lds_dwordx4 v62, s[30:31]
    s_mov_b32 m0, 59136
    v_add_u32 v63, 688128, v59
    global_load_lds_dwordx4 v63, s[30:31]
    s_mov_b32 m0, 60160
    v_add_u32 v60, 745472, v59
    global_load_lds_dwordx4 v60, s[30:31]
    s_branch L_DMAf_DONE
L_DMAf2:
    s_cmp_lg_u32 s3, 6
    s_cbranch_scc1 L_DMAf3
    s_mov_b32 m0, 61184
    v_add_u32 v60, 802816, v59
    global_load_lds_dwordx4 v60, s[30:31]
    s_mov_b32 m0, 62208
    v_add_u32 v61, 860160, v59
    global_load_lds_dwordx4 v61, s[30:31]
    s_mov_b32 m0, 63232
    v_add_u32 v62, 917504, v59
    global_load_lds_dwordx4 v62, s[30:31]
    s_mov_b32 m0, 64256
    v_add_u32 v63, 974848, v59
    global_load_lds_dwordx4 v63, s[30:31]
    s_mov_b32 m0, 65280
    v_add_u32 v60, 1032192, v59
    global_load_lds_dwordx4 v60, s[30:31]
    s_mov_b32 m0, 66304
    v_add_u32 v61, 1089536, v59
    global_load_lds_dwordx4 v61, s[30:31]
    s_mov_b32 m0, 67328
    v_add_u32 v62, 1146880, v59
    global_load_lds_dwordx4 v62, s[30:31]
    s_mov_b32 m0, 68352
    v_add_u32 v63, 1204224, v59
    global_load_lds_dwordx4 v63, s[30:31]
    s_mov_b32 m0, 69376
    v_add_u32 v60, 1261568, v59
    global_load_lds_dwordx4 v60, s[30:31]
    s_mov_b32 m0, 70400
    v_add_u32 v61, 1318912, v59
    global_load_lds_dwordx4 v61, s[30:31]
    s_mov_b32 m0, 71424
    v_add_u32 v62, 1376256, v59
    global_load_lds_dwordx4 v62, s[30:31]
    s_mov_b32 m0, 72448
    v_add_u32 v63, 1433600, v59
    global_load_lds_dwordx4 v63, s[30:31]
    s_mov_b32 m0, 73472
    v_add_u32 v60, 1490944, v59
    global_load_lds_dwordx4 v60, s[30:31]
    s_mov_b32 m0, 74496
    v_add_u32 v61, 1548288, v59
    global_load_lds_dwordx4 v61, s[30:31]
    s_mov_b32 m0, 75520
    v_add_u32 v62, 0, v58
    global_load_lds_dwordx4 v62, s[32:33]
    s_mov_b32 m0, 76544
    v_add_u32 v63, 1024, v58
    global_load_lds_dwordx4 v63, s[32:33]
    s_mov_b32 m0, 77568
    v_add_u32 v60, 2048, v58
    global_load_lds_dwordx4 v60, s[32:33]
    s_mov_b32 m0, 78592
    v_add_u32 v61, 3072, v58
    global_load_lds_dwordx4 v61, s[32:33]
    s_mov_b32 m0, 79616
    v_add_u32 v62, 4096, v58
    global_load_lds_dwordx4 v62, s[32:33]
    s_mov_b32 m0, 80640
    v_add_u32 v63, 5120, v58
    global_load_lds_dwordx4 v63, s[32:33]
    s_mov_b32 m0, 81664
    v_add_u32 v60, 6144, v58
    global_load_lds_dwordx4 v60, s[32:33]
    s_branch L_DMAf_DONE
L_DMAf3:
    s_mov_b32 m0, 82688
    v_add_u32 v60, 7168, v58
    global_load_lds_dwordx4 v60, s[32:33]
    s_mov_b32 m0, 83712
    v_add_u32 v61, 8192, v58
    global_load_lds_dwordx4 v61, s[32:33]
    s_mov_b32 m0, 84736
    v_add_u32 v62, 9216, v58
    global_load_lds_dwordx4 v62, s[32:33]
    s_mov_b32 m0, 85760
    v_add_u32 v63, 10240, v58
    global_load_lds_dwordx4 v63, s[32:33]
    s_mov_b32 m0, 86784
    v_add_u32 v60, 11264, v58
    global_load_lds_dwordx4 v60, s[32:33]
    s_mov_b32 m0, 87808
    v_add_u32 v61, 12288, v58
    global_load_lds_dwordx4 v61, s[32:33]
    s_mov_b32 m0, 88832
    v_add_u32 v62, 13312, v58
    global_load_lds_dwordx4 v62, s[32:33]
    s_mov_b32 m0, 89856
    v_add_u32 v63, 14336, v58
    global_load_lds_dwordx4 v63, s[32:33]
    s_mov_b32 m0, 90880
    v_add_u32 v60, 15360, v58
    global_load_lds_dwordx4 v60, s[32:33]
    s_mov_b32 m0, 91904
    v_add_u32 v61, 16384, v58
    global_load_lds_dwordx4 v61, s[32:33]
    s_mov_b32 m0, 92928
    v_add_u32 v62, 17408, v58
    global_load_lds_dwordx4 v62, s[32:33]
    s_mov_b32 m0, 93952
    v_add_u32 v63, 18432, v58
    global_load_lds_dwordx4 v63, s[32:33]
    s_mov_b32 m0, 94976
    v_add_u32 v60, 19456, v58
    global_load_lds_dwordx4 v60, s[32:33]
    s_mov_b32 m0, 96000
    v_add_u32 v61, 20480, v58
    global_load_lds_dwordx4 v61, s[32:33]
    s_mov_b32 m0, 97024
    v_add_u32 v62, 21504, v58
    global_load_lds_dwordx4 v62, s[32:33]
    s_mov_b32 m0, 98048
    v_add_u32 v63, 22528, v58
    global_load_lds_dwordx4 v63, s[32:33]
    s_mov_b32 m0, 99072
    v_add_u32 v60, 23552, v58
    global_load_lds_dwordx4 v60, s[32:33]
    s_mov_b32 m0, 100096
    v_add_u32 v61, 24576, v58
    global_load_lds_dwordx4 v61, s[32:33]
    s_mov_b32 m0, 101120
    v_add_u32 v62, 25600, v58
    global_load_lds_dwordx4 v62, s[32:33]
    s_mov_b32 m0, 102144
    v_add_u32 v63, 26624, v58
    global_load_lds_dwordx4 v63, s[32:33]
    s_mov_b32 m0, 103168
    v_add_u32 v60, 27648, v58
    global_load_lds_dwordx4 v60, s[32:33]
L_DMAf_DONE:
    s_waitcnt vmcnt(0)
    s_barrier
L_END:
L_END2:
s_endpgm
.section .rodata,"a"
.p2align 6
.amdhsa_kernel sequential_preLN__gqa_block_cached__geglu_ffn__decode_kernel
  .amdhsa_next_free_vgpr 256
  .amdhsa_next_free_sgpr 102
  .amdhsa_accum_offset 256
  .amdhsa_group_segment_fixed_size 0
  .amdhsa_kernarg_size 96
  .amdhsa_user_sgpr_count 2
  .amdhsa_user_sgpr_kernarg_segment_ptr 1
  .amdhsa_system_sgpr_workgroup_id_x 1
.end_amdhsa_kernel
```
